```python
import torch

def _softmax(x, axis=-1):
    return torch.softmax(x, dim=axis)
def _gelu(x):
    return torch.nn.functional.gelu(x, approximate="tanh")
def _silu(x):
    return torch.nn.functional.silu(x)
def _sigmoid(x):
    return torch.sigmoid(x)
def _layernorm(x, axis=-1, eps=1e-5):
    m = x.mean(dim=axis, keepdim=True)
    v = x.var(dim=axis, keepdim=True, unbiased=False)
    return (x - m) / torch.sqrt(v + eps)
def _scatter_add(tgt, idx, src, axis=0):
    return tgt.clone().index_add_(axis, idx, src)
def _segment_sum(src, seg, n):
    out = torch.zeros((n,) + src.shape[1:], dtype=src.dtype)
    return out.index_add_(0, seg, src)
def _pad(x, pw):
    flat = tuple(v for pair in reversed(pw) for v in pair)
    return torch.nn.functional.pad(x, flat)

kernel_name = 'gated_mix__spectral_fnet__glu_gated_glu__prompt'

def setup_inputs():

    _w = (lambda a: (lambda t: t.to(torch.bfloat16) if t.is_floating_point() else t)(torch.as_tensor(a)))
    def _A_setup():
        B, S, D = 1, 2048, 448
        ns = torch.arange(S)[:, None] * torch.arange(S)[None, :]
        nd = torch.arange(D)[:, None] * torch.arange(D)[None, :]
        Ws_re = torch.cos(-2.0 * torch.pi * ns / S).to(float)
        Ws_im = torch.sin(-2.0 * torch.pi * ns / S).to(float)
        Wd_re = torch.cos(-2.0 * torch.pi * nd / D).to(float)
        Wd_im = torch.sin(-2.0 * torch.pi * nd / D).to(float)
        return {
            "x": _w((lambda *s: torch.randn(*s, dtype=torch.bfloat16) * 0.05)(B, S, D)),
            "dft_seq_re": _w(Ws_re),
            "dft_seq_im": _w(Ws_im),
            "dft_hid_re": _w(Wd_re),
            "dft_hid_im": _w(Wd_im),
        }
    _A_in = _A_setup()

    def _B_setup():
        B, S, D, F = 1, 2048, 448, 1792
        return {
            "x": _w((lambda *s: torch.randn(*s, dtype=torch.bfloat16) * 0.05)(B, S, D)),
            "w_gate": _w((lambda *s: torch.randn(*s, dtype=torch.bfloat16) * 1.6)(D, F)),
            "w_up": _w((lambda *s: torch.randn(*s, dtype=torch.bfloat16) * 0.8)(D, F)),
            "w_down": _w((lambda *s: torch.randn(*s, dtype=torch.bfloat16) * 0.8)(F, D)),
        }
    _B_in = _B_setup()

    return {
        "A_x": _A_in["x"],
        "A_dft_seq_re": _A_in["dft_seq_re"],
        "A_dft_seq_im": _A_in["dft_seq_im"],
        "A_dft_hid_re": _A_in["dft_hid_re"],
        "A_dft_hid_im": _A_in["dft_hid_im"],
        "B_x": _B_in["x"],
        "B_w_gate": _B_in["w_gate"],
        "B_w_up": _B_in["w_up"],
        "B_w_down": _B_in["w_down"],
        "gate_w": _w((lambda *s: torch.randn(*s, dtype=torch.bfloat16) * 0.05)(448) * 16.0),
    }

def reference(A_x, A_dft_seq_re, A_dft_seq_im, A_dft_hid_re, A_dft_hid_im, B_x, B_w_gate, B_w_up, B_w_down, gate_w):
    def _A_ref(x, dft_seq_re, dft_seq_im, dft_hid_re, dft_hid_im):
        a = torch.einsum("bsd,ed->bse", x, dft_hid_re)
        b = torch.einsum("bsd,ed->bse", x, dft_hid_im)
        y = torch.einsum("ts,bse->bte", dft_seq_re, a) - torch.einsum("ts,bse->bte", dft_seq_im, b)
        return y

    def _B_ref(x, w_gate, w_up, w_down):
        g = torch.einsum("bsd,df->bsf", x, w_gate)
        u = torch.einsum("bsd,df->bsf", x, w_up)
        h = _sigmoid(g) * u
        return torch.einsum("bsf,fd->bsd", h, w_down)

    x = A_x
    g = _sigmoid((x * gate_w).sum(-1, keepdims=True))
    a = _A_ref(x, A_dft_seq_re, A_dft_seq_im, A_dft_hid_re, A_dft_hid_im)
    b = _B_ref(x, B_w_gate, B_w_up, B_w_down)
    return g * a + (1 - g) * b
```

```asm
; @launch grid=(256,1,1) block=(256,1,1) lds=163840
.amdgcn_target "amdgcn-amd-amdhsa--gfx950"
.text
.globl gated_mix__spectral_fnet__glu_gated_glu__prompt_kernel
.p2align 8
.type gated_mix__spectral_fnet__glu_gated_glu__prompt_kernel,@function
gated_mix__spectral_fnet__glu_gated_glu__prompt_kernel:
    s_load_dwordx16 s[64:79], s[0:1], 0
    s_getpc_b64 s[90:91]
    v_and_b32 v2, 63, v0
    v_lshrrev_b32 v3, 6, v0
    s_lshr_b32 s5, s2, 3
    v_lshl_add_u32 v3, s5, 2, v3
    v_lshl_add_u32 v3, v3, 1, v2
    v_cmp_gt_u32 vcc, 20, v2
    v_cmp_gt_u32 s[6:7], 22, v2
    v_add_u32 v62, (L_a1-gated_mix__spectral_fnet__glu_gated_glu__prompt_kernel)/128-22, v2
    v_cndmask_b32 v3, v3, v2, vcc
    v_cmp_gt_u32 vcc, 34, v2
    v_cndmask_b32 v3, v62, v3, s[6:7]
    v_lshlrev_b32 v3, 7, v3
    v_min_u32 v3, L_code_end-gated_mix__spectral_fnet__glu_gated_glu__prompt_kernel-32, v3
    v_cndmask_b32 v62, 0, v3, vcc
    global_load_dword v62, v62, s[90:91]
    s_load_dwordx8 s[80:87], s[0:1], 64
    s_load_dwordx2 s[88:89], s[0:1], 96
    s_cmp_ge_u32 s2, 256
    s_cbranch_scc1 L_done
    v_lshrrev_b32 v2, 6, v0
    v_and_b32 v1, 63, v0
    s_mov_b32 s63, s2
    v_readfirstlane_b32 s4, v2
    s_and_b32 s3, s2, 7
    s_lshr_b32 s2, s2, 3
    v_lshrrev_b32 v2, 3, v1
    v_and_b32 v3, 7, v1
    v_lshrrev_b32 v48, 4, v1
    s_lshl_b32 s11, s4, 12
    s_add_u32 s10, s11, 81920
    v_xor_b32 v49, v48, v3
    s_cmp_lt_u32 s2, 4
    s_cbranch_scc1 L_a1
    s_sub_u32 s2, s2, 4
    s_and_b32 s60, s2, 3
    s_lshr_b32 s59, s2, 2
    s_lshr_b32 s5, s3, 1
    s_lshl2_add_u32 s57, s5, s60
    s_and_b32 s3, s3, 1
    s_mul_i32 s6, s3, 7
    s_add_u32 s56, s59, s6
    s_lshr_b32 s62, s59, 2
    s_mul_i32 s99, s62, 3
    s_lshl1_add_u32 s99, s60, s99
    s_sub_u32 s62, s99, 7
    s_cselect_b32 s99, s99, s62
    s_lshl_b32 s99, s99, 7
    s_mov_b32 s92, s99
    s_lshl2_add_u32 s58, s57, s4
    s_lshr_b32 s8, s58, 1
    s_mul_i32 s8, s8, 896
    s_and_b32 s5, s4, 1
    s_mul_i32 s6, s5, 917504
    s_add_u32 s8, s8, s6
    s_mul_i32 s9, s5, 114688
    s_lshl_b32 s6, s56, 8
    s_add_u32 s9, s9, s6
    s_add_u32 s61, s9, 128
    v_mul_u32_u24 v50, 28672, v2
    v_xor_b32 v51, 4, v49
    v_lshl_add_u32 v4, v49, 4, v50
    v_lshl_add_u32 v51, v51, 4, v50
    v_add_u32 v5, 228352, v51
    v_add_u32 v6, 456704, v4
    v_add_u32 v7, 685056, v51
    v_mul_u32_u24 v50, 3584, v2
    v_lshlrev_b32 v51, 2, v48
    v_and_b32 v51, 4, v51
    v_xor_b32 v51, v51, v3
    v_lshl_add_u32 v8, v51, 4, v50
    v_add_u32 v9, 27648, v8
    v_add_u32 v10, 55296, v8
    v_add_u32 v11, 82944, v8
    s_mov_b32 s22, 1605632
    s_mov_b32 s23, 0x20000
    s_mov_b32 s14, 1835008
    s_mov_b32 s15, 0x20000
    s_cmp_lt_u32 s4, 2
    s_waitcnt lgkmcnt(0)
    s_cselect_b32 s20, s76, s78
    s_cselect_b32 s21, s77, s79
    s_mov_b32 s12, s64
    s_mov_b32 s13, s65
    s_add_u32 m0, s10, 0
    s_add_u32 s74, s8, s92
    buffer_load_dwordx4 v4, s[12:15], s74 offen lds
    buffer_load_dwordx4 v5, s[12:15], s74 offen offset:1024 lds
    buffer_load_dwordx4 v6, s[12:15], s74 offen offset:2048 lds
    buffer_load_dwordx4 v7, s[12:15], s74 offen offset:3072 lds
    s_add_u32 m0, s11, 0
    s_mul_i32 s75, s92, 1792
    s_add_u32 s75, s75, s9
    buffer_load_dwordx4 v8, s[20:23], s75 offen lds
    buffer_load_dwordx4 v9, s[20:23], s75 offen offset:1024 lds
    buffer_load_dwordx4 v10, s[20:23], s75 offen offset:2048 lds
    buffer_load_dwordx4 v11, s[20:23], s75 offen offset:3072 lds
    s_add_u32 s92, s99, 0
    s_sub_u32 s62, s92, 896
    s_cselect_b32 s92, s92, s62
    s_add_u32 s93, s99, 128
    s_sub_u32 s62, s93, 896
    s_cselect_b32 s93, s93, s62
    s_add_u32 s94, s99, 256
    s_sub_u32 s62, s94, 896
    s_cselect_b32 s94, s94, s62
    s_add_u32 s95, s99, 384
    s_sub_u32 s62, s95, 896
    s_cselect_b32 s95, s95, s62
    s_add_u32 s96, s99, 512
    s_sub_u32 s62, s96, 896
    s_cselect_b32 s96, s96, s62
    s_add_u32 s97, s99, 640
    s_sub_u32 s62, s97, 896
    s_cselect_b32 s97, s97, s62
    s_add_u32 s98, s99, 768
    s_sub_u32 s62, s98, 896
    s_cselect_b32 s98, s98, s62
    s_lshr_b32 s6, s4, 1
    s_lshl_b32 s6, s6, 13
    s_add_u32 s6, s6, 81920
    v_and_b32 v2, 31, v1
    v_lshrrev_b32 v3, 5, v1
    v_bfe_u32 v48, v2, 1, 3
    v_xor_b32 v48, v48, v3
    v_lshlrev_b32 v48, 4, v48
    v_lshl_add_u32 v12, v2, 7, v48
    v_xor_b32 v13, 32, v12
    v_xor_b32 v14, 64, v12
    v_xor_b32 v15, 96, v12
    v_add_u32 v20, s6, v12
    v_add_u32 v21, s6, v13
    v_add_u32 v22, s6, v14
    v_add_u32 v23, s6, v15
    v_add_u32 v24, 65536, v20
    v_add_u32 v25, 65536, v21
    v_add_u32 v26, 65536, v22
    v_add_u32 v27, 65536, v23
    v_lshrrev_b32 v2, 5, v1
    v_bfe_u32 v3, v1, 2, 2
    v_lshlrev_b32 v2, 3, v2
    v_add_u32 v2, v2, v3
    v_lshlrev_b32 v2, 7, v2
    v_bfe_u32 v3, v1, 3, 1
    v_lshl_add_u32 v2, v3, 6, v2
    v_bfe_u32 v3, v1, 4, 1
    v_lshl_add_u32 v2, v3, 5, v2
    v_and_b32 v3, 3, v1
    v_lshl_add_u32 v16, v3, 3, v2
    s_and_b32 s6, s4, 1
    s_lshl_b32 s6, s6, 6
    v_xor_b32 v16, s6, v16
    v_add_u32 v12, 65536, v16
    v_lshlrev_b32 v28, 4, v1
    v_add_u32 v0, 4096, v28
    s_add_u32 m0, s11, 16384
    s_mul_i32 s75, s93, 1792
    s_add_u32 s75, s75, s9
    buffer_load_dwordx4 v8, s[20:23], s75 offen lds
    s_mov_b32 s24, s88
    s_mov_b32 s25, s89
    s_mov_b32 s26, 8388608
    s_mov_b32 s27, 0x20000
    buffer_load_dwordx4 v9, s[20:23], s75 offen offset:1024 lds
    s_mov_b32 s16, s80
    s_mov_b32 s17, s81
    s_mov_b32 s18, 1605632
    s_mov_b32 s19, 0x20000
    s_add_u32 s28, s88, 8388608
    s_addc_u32 s29, s89, 0
    s_mov_b32 s30, 2097152
    s_mov_b32 s31, 0x20000
    buffer_load_dwordx4 v10, s[20:23], s75 offen offset:2048 lds
    s_add_u32 s36, s88, 10485760
    s_addc_u32 s37, s89, 0
    s_mov_b32 s38, 8192
    s_mov_b32 s39, 0x20000
    buffer_load_dwordx4 v11, s[20:23], s75 offen offset:3072 lds
    s_mov_b32 s40, s84
    s_mov_b32 s41, s85
    s_mov_b32 s42, 1835008
    s_mov_b32 s43, 0x20000
    s_add_u32 m0, s10, 16384
    s_add_u32 s74, s8, s93
    buffer_load_dwordx4 v4, s[12:15], s74 offen lds
    s_add_u32 s44, s88, 11534336
    s_addc_u32 s45, s89, 0
    s_mov_b32 s46, 245760
    s_mov_b32 s47, 0x20000
    s_mov_b32 s48, s86
    s_mov_b32 s49, s87
    s_mov_b32 s50, 256
    s_mov_b32 s51, 0x20000
    buffer_load_dwordx4 v5, s[12:15], s74 offen offset:1024 lds
    s_add_u32 s32, s88, 13631488
    s_addc_u32 s33, s89, 0
    s_mov_b32 s34, 3670016
    s_mov_b32 s35, 0x20000
    buffer_load_dwordx4 v6, s[12:15], s74 offen offset:2048 lds
    s_and_b32 s52, s58, -2
    s_mul_i32 s52, s52, 64
    s_lshl_b32 s5, s56, 2
    s_add_u32 s52, s52, s5
    s_and_b32 s5, s4, 1
    s_add_u32 s52, s52, s5
    s_lshl_b32 s52, s52, 11
    s_add_u32 s53, s52, 131072
    s_mov_b32 s54, 0xbfb8aa3b
    s_mov_b32 s88, s3
    s_getreg_b32 s89, hwreg(HW_REG_XCC_ID, 0, 4)
    s_mul_i32 s57, s57, 14
    s_add_u32 s5, s57, s56
    s_lshl_b32 s5, s5, 2
    s_add_u32 s5, s5, s4
    s_lshl_b32 s82, s5, 12
    s_mul_i32 s6, s88, 14
    s_add_u32 s7, s56, 7
    s_sub_u32 s7, s7, s6
    s_add_u32 s7, s7, s57
    s_lshl_b32 s7, s7, 2
    s_add_u32 s7, s7, s4
    s_lshl_b32 s81, s7, 12
    s_lshl_b32 s83, s7, 7
    s_add_u32 s83, s83, 131072
    s_lshl_b32 s56, s5, 7
    s_mul_i32 s6, s88, 7
    s_add_u32 s57, s57, s6
    s_lshl_b32 s57, s57, 9
    buffer_load_dwordx4 v7, s[12:15], s74 offen offset:3072 lds
    s_lshl_b32 s84, s60, 1
    s_add_u32 s84, s84, s59
    s_sub_u32 s86, s84, 7
    s_cselect_b32 s84, s84, s86
    s_mul_i32 s85, s88, 7
    s_add_u32 s86, s84, 0
    s_sub_u32 s87, s86, 7
    s_cselect_b32 s86, s86, s87
    s_add_u32 s64, s86, s85
    s_add_u32 s86, s84, 1
    s_sub_u32 s87, s86, 7
    s_cselect_b32 s86, s86, s87
    s_add_u32 s65, s86, s85
    s_add_u32 s86, s84, 2
    s_sub_u32 s87, s86, 7
    s_cselect_b32 s86, s86, s87
    s_add_u32 s66, s86, s85
    s_add_u32 s86, s84, 3
    s_sub_u32 s87, s86, 7
    s_cselect_b32 s86, s86, s87
    s_add_u32 s67, s86, s85
    s_add_u32 s86, s84, 4
    s_sub_u32 s87, s86, 7
    s_cselect_b32 s86, s86, s87
    s_add_u32 s68, s86, s85
    s_add_u32 s86, s84, 5
    s_sub_u32 s87, s86, 7
    s_cselect_b32 s86, s86, s87
    s_add_u32 s69, s86, s85
    s_add_u32 s86, s84, 6
    s_sub_u32 s87, s86, 7
    s_cselect_b32 s86, s86, s87
    s_add_u32 s70, s86, s85
    s_mul_i32 s71, s58, 131072
    s_mul_i32 s72, s4, 14336
    s_lshl_b32 s86, s59, 7
    s_add_u32 s72, s72, s86
    s_add_u32 s73, s72, 57344
    s_lshl_b32 s77, s4, 11
    s_add_u32 s76, s77, 81920
    s_and_b32 s79, s58, 1
    s_lshl_b32 s79, s79, 10
    s_lshr_b32 s58, s58, 1
    s_add_u32 s79, s79, s58
    s_lshl_b32 s78, s59, 6
    s_lshl_b32 s86, s88, 5
    s_add_u32 s78, s78, s86
    v_lshrrev_b32 v2, 3, v1
    v_and_b32 v3, 7, v1
    v_bfe_u32 v48, v1, 4, 1
    v_lshlrev_b32 v48, 2, v48
    v_xor_b32 v48, v48, v3
    v_lshlrev_b32 v48, 4, v48
    v_mul_u32_u24 v49, 896, v2
    v_add_u32 v30, v48, v49
    v_add_u32 v31, 6144, v30
    v_and_b32 v2, 31, v1
    v_lshrrev_b32 v3, 5, v1
    v_add_u32 v48, s78, v2
    v_sub_u32 v49, 448, v48
    s_sub_u32 s86, 32, s58
    s_and_b32 s86, s86, 31
    s_cmp_ge_u32 s78, 224
    s_cselect_b32 s86, s86, s58
    s_cselect_b64 vcc, -1, 0
    s_mov_b32 s87, 0x3e800000
    s_cselect_b32 s87, 0x3f400000, s87
    v_cndmask_b32 v48, v48, v49, vcc
    s_lshl_b32 s86, s86, 16
    v_lshlrev_b32 v38, 5, v48
    v_add_u32 v38, s86, v38
    v_lshl_add_u32 v38, v3, 4, v38
    v_lshl_add_u32 v48, v2, 5, s79
    v_and_b32 v49, 63, v48
    v_lshrrev_b32 v50, 6, v48
    v_lshl_add_u32 v49, v49, 5, v50
    v_lshlrev_b32 v41, 2, v49
    v_mul_u32_u24 v42, 896, v48
    v_lshl_add_u32 v42, v3, 4, v42
    s_lshl_b32 s86, s78, 1
    v_add_u32 v42, s86, v42
    v_cvt_f32_u32 v40, v48
    v_mul_f32 v40, 0x3a000000, v40
    v_cvt_f32_u32 v45, v3
    v_mul_f32 v45, s87, v45
    v_bfe_u32 v48, v1, 2, 2
    v_lshl_add_u32 v48, v3, 2, v48
    v_lshlrev_b32 v48, 7, v48
    v_bfe_u32 v49, v1, 3, 1
    v_lshl_add_u32 v48, v49, 6, v48
    v_bfe_u32 v49, v1, 4, 1
    v_lshl_add_u32 v48, v49, 5, v48
    v_and_b32 v49, 3, v1
    v_lshl_add_u32 v48, v49, 3, v48
    s_lshl_b32 s86, s88, 6
    v_xor_b32 v49, s86, v48
    v_xor_b32 v48, 64, v49
    v_add_u32 v32, 0, v48
    v_add_u32 v33, 65536, v48
    v_add_u32 v34, 131072, v48
    v_add_u32 v35, 0, v49
    v_add_u32 v36, 65536, v49
    v_add_u32 v37, 131072, v49
    v_lshrrev_b32 v48, 1, v1
    v_and_b32 v49, 1, v1
    v_lshl_add_u32 v48, v48, 2, v49
    s_lshr_b32 s86, s4, 1
    s_lshl_b32 s86, s86, 1
    v_add_u32 v48, s86, v48
    v_lshlrev_b32 v43, 7, v48
    v_lshlrev_b32 v44, 9, v1
    v_add_u32 v44, 131072, v44
    s_mov_b32 s84, 0xbfb8aa3b
    s_mov_b32 s85, 0xbfb8aa3b
    s_mov_b32 s86, 1.0
    s_mov_b32 s87, 1.0
    s_sub_u32 s5, s63, 32
    s_lshl_b32 s6, s5, 2
    s_add_u32 s6, s6, s4
    s_mul_i32 s6, s6, 14
    v_add_u32 v48, s6, v1
    v_lshlrev_b32 v48, 7, v48
    v_mov_b32 v49, 0x7fffff00
    v_cmp_gt_u32 vcc, 14, v1
    s_nop 1
    v_cndmask_b32 v48, v49, v48, vcc
    buffer_load_dword v62, v48, s[16:19], 0 offen
    s_sub_u32 s5, s63, 32
    s_lshl_b32 s5, s5, 1
    s_and_b32 s6, s4, 1
    s_add_u32 s5, s5, s6
    s_mul_i32 s5, s5, 3584
    s_add_u32 s5, s5, 128
    v_lshlrev_b32 v48, 8, v1
    v_mov_b32 v49, 0x7fffff00
    v_cmp_gt_u32 vcc, 14, v1
    s_nop 1
    v_cndmask_b32 v48, v49, v48, vcc
    buffer_load_dword v62, v48, s[20:23], s5 offen
    v_lshlrev_b32 v48, 21, v1
    v_cmp_gt_u32 vcc, 9, v1
    s_nop 1
    v_cndmask_b32 v48, 0, v48, vcc
    v_add_u32 v48, 2097024, v48
    global_load_dword v62, v48, s[24:25]
    buffer_load_dword v62, off, s[40:43], 0
    buffer_load_dword v18, off, s[48:51], 0 sc1
    s_waitcnt vmcnt(13)
    s_barrier
    ds_read_b64_tr_b16 a[224:225], v16 offset:0
    ds_read_b64_tr_b16 a[226:227], v16 offset:512
    ds_read_b128 a[0:3], v20 offset:0
    ds_read_b128 a[4:7], v20 offset:4096
    ds_read_b64_tr_b16 a[228:229], v16 offset:8192
    ds_read_b64_tr_b16 a[230:231], v16 offset:8704
    s_waitcnt lgkmcnt(3)
    v_mfma_f32_32x32x16_bf16 v[64:79], a[224:227], a[0:3], 0
    ds_read_b64_tr_b16 a[232:233], v16 offset:2048
    ds_read_b64_tr_b16 a[234:235], v16 offset:2560
    ds_read_b128 a[8:11], v21 offset:0
    s_waitcnt lgkmcnt(5)
    v_mfma_f32_32x32x16_bf16 v[80:95], a[224:227], a[4:7], 0
    ds_read_b128 a[12:15], v21 offset:4096
    s_waitcnt lgkmcnt(4)
    v_mfma_f32_32x32x16_bf16 v[96:111], a[228:231], a[0:3], 0
    ds_read_b64_tr_b16 a[236:237], v16 offset:10240
    ds_read_b64_tr_b16 a[238:239], v16 offset:10752
    v_mfma_f32_32x32x16_bf16 v[112:127], a[228:231], a[4:7], 0
    s_waitcnt lgkmcnt(3)
    v_mfma_f32_32x32x16_bf16 v[64:79], a[232:235], a[8:11], v[64:79]
    ds_read_b64_tr_b16 a[224:225], v16 offset:4096
    ds_read_b64_tr_b16 a[226:227], v16 offset:4608
    ds_read_b128 a[16:19], v22 offset:0
    s_add_u32 m0, s10, 32768
    s_add_u32 s74, s8, s94
    buffer_load_dwordx4 v4, s[12:15], s74 offen lds
    s_waitcnt lgkmcnt(5)
    v_mfma_f32_32x32x16_bf16 v[80:95], a[232:235], a[12:15], v[80:95]
    ds_read_b128 a[20:23], v22 offset:4096
    buffer_load_dwordx4 v5, s[12:15], s74 offen offset:1024 lds
    s_waitcnt lgkmcnt(4)
    v_mfma_f32_32x32x16_bf16 v[96:111], a[236:239], a[8:11], v[96:111]
    ds_read_b64_tr_b16 a[228:229], v16 offset:12288
    ds_read_b64_tr_b16 a[230:231], v16 offset:12800
    buffer_load_dwordx4 v6, s[12:15], s74 offen offset:2048 lds
    v_mfma_f32_32x32x16_bf16 v[112:127], a[236:239], a[12:15], v[112:127]
    buffer_load_dwordx4 v7, s[12:15], s74 offen offset:3072 lds
    s_waitcnt lgkmcnt(3)
    v_mfma_f32_32x32x16_bf16 v[64:79], a[224:227], a[16:19], v[64:79]
    ds_read_b64_tr_b16 a[232:233], v16 offset:6144
    ds_read_b64_tr_b16 a[234:235], v16 offset:6656
    ds_read_b128 a[24:27], v23 offset:0
    s_add_u32 m0, s11, 32768
    s_mul_i32 s75, s94, 1792
    s_add_u32 s75, s75, s9
    buffer_load_dwordx4 v8, s[20:23], s75 offen lds
    s_waitcnt lgkmcnt(5)
    v_mfma_f32_32x32x16_bf16 v[80:95], a[224:227], a[20:23], v[80:95]
    ds_read_b128 a[28:31], v23 offset:4096
    buffer_load_dwordx4 v9, s[20:23], s75 offen offset:1024 lds
    s_waitcnt lgkmcnt(4)
    v_mfma_f32_32x32x16_bf16 v[96:111], a[228:231], a[16:19], v[96:111]
    ds_read_b64_tr_b16 a[236:237], v16 offset:14336
    ds_read_b64_tr_b16 a[238:239], v16 offset:14848
    buffer_load_dwordx4 v10, s[20:23], s75 offen offset:2048 lds
    v_mfma_f32_32x32x16_bf16 v[112:127], a[228:231], a[20:23], v[112:127]
    buffer_load_dwordx4 v11, s[20:23], s75 offen offset:3072 lds
    s_waitcnt vmcnt(13)
    s_barrier
    s_waitcnt lgkmcnt(3)
    v_mfma_f32_32x32x16_bf16 v[64:79], a[232:235], a[24:27], v[64:79]
    ds_read_b64_tr_b16 a[224:225], v16 offset:16384
    ds_read_b64_tr_b16 a[226:227], v16 offset:16896
    ds_read_b128 a[32:35], v20 offset:16384
    s_add_u32 m0, s10, 49152
    s_add_u32 s74, s8, s95
    buffer_load_dwordx4 v4, s[12:15], s74 offen lds
    s_waitcnt lgkmcnt(5)
    v_mfma_f32_32x32x16_bf16 v[80:95], a[232:235], a[28:31], v[80:95]
    ds_read_b128 a[36:39], v20 offset:20480
    s_waitcnt vmcnt(9)
    v_readfirstlane_b32 s55, v18
    s_nop 3
    s_cmp_lg_u32 s55, 0
    s_cbranch_scc1 L_tok_ok_1
    s_mov_b32 s62, 0x40000
L_tok_lp_2:
    s_sleep 2
    buffer_load_dword v18, off, s[48:51], 0 sc1
    s_waitcnt vmcnt(0)
    v_readfirstlane_b32 s55, v18
    s_sub_u32 s62, s62, 1
    s_cmp_eq_u32 s62, 0
    s_cbranch_scc1 L_tok_ok_1
    s_cmp_eq_u32 s55, 0
    s_cbranch_scc1 L_tok_lp_2
L_tok_ok_1:
    v_mov_b32 v61, s55
    s_waitcnt lgkmcnt(4)
    v_mfma_f32_32x32x16_bf16 v[96:111], a[236:239], a[24:27], v[96:111]
    ds_read_b64_tr_b16 a[228:229], v16 offset:24576
    ds_read_b64_tr_b16 a[230:231], v16 offset:25088
    buffer_load_dwordx4 v5, s[12:15], s74 offen offset:1024 lds
    v_mfma_f32_32x32x16_bf16 v[112:127], a[236:239], a[28:31], v[112:127]
    s_waitcnt lgkmcnt(3)
    v_mfma_f32_32x32x16_bf16 v[64:79], a[224:227], a[32:35], v[64:79]
    ds_read_b64_tr_b16 a[232:233], v16 offset:18432
    ds_read_b64_tr_b16 a[234:235], v16 offset:18944
    ds_read_b128 a[40:43], v21 offset:16384
    buffer_load_dwordx4 v6, s[12:15], s74 offen offset:2048 lds
    s_waitcnt lgkmcnt(5)
    v_mfma_f32_32x32x16_bf16 v[80:95], a[224:227], a[36:39], v[80:95]
    ds_read_b128 a[44:47], v21 offset:20480
    s_waitcnt lgkmcnt(4)
    v_mfma_f32_32x32x16_bf16 v[96:111], a[228:231], a[32:35], v[96:111]
    ds_read_b64_tr_b16 a[236:237], v16 offset:26624
    ds_read_b64_tr_b16 a[238:239], v16 offset:27136
    buffer_load_dwordx4 v7, s[12:15], s74 offen offset:3072 lds
    v_mfma_f32_32x32x16_bf16 v[112:127], a[228:231], a[36:39], v[112:127]
    s_waitcnt lgkmcnt(3)
    v_mfma_f32_32x32x16_bf16 v[64:79], a[232:235], a[40:43], v[64:79]
    ds_read_b64_tr_b16 a[224:225], v16 offset:20480
    ds_read_b64_tr_b16 a[226:227], v16 offset:20992
    ds_read_b128 a[48:51], v22 offset:16384
    s_add_u32 m0, s11, 49152
    s_mul_i32 s75, s95, 1792
    s_add_u32 s75, s75, s9
    buffer_load_dwordx4 v8, s[20:23], s75 offen lds
    s_waitcnt lgkmcnt(5)
    v_mfma_f32_32x32x16_bf16 v[80:95], a[232:235], a[44:47], v[80:95]
    ds_read_b128 a[52:55], v22 offset:20480
    s_waitcnt lgkmcnt(4)
    v_mfma_f32_32x32x16_bf16 v[96:111], a[236:239], a[40:43], v[96:111]
    ds_read_b64_tr_b16 a[228:229], v16 offset:28672
    ds_read_b64_tr_b16 a[230:231], v16 offset:29184
    buffer_load_dwordx4 v9, s[20:23], s75 offen offset:1024 lds
    v_mfma_f32_32x32x16_bf16 v[112:127], a[236:239], a[44:47], v[112:127]
    s_waitcnt lgkmcnt(3)
    v_mfma_f32_32x32x16_bf16 v[64:79], a[224:227], a[48:51], v[64:79]
    ds_read_b64_tr_b16 a[232:233], v16 offset:22528
    ds_read_b64_tr_b16 a[234:235], v16 offset:23040
    ds_read_b128 a[56:59], v23 offset:16384
    buffer_load_dwordx4 v10, s[20:23], s75 offen offset:2048 lds
    s_waitcnt lgkmcnt(5)
    v_mfma_f32_32x32x16_bf16 v[80:95], a[224:227], a[52:55], v[80:95]
    ds_read_b128 a[60:63], v23 offset:20480
    s_waitcnt lgkmcnt(4)
    v_mfma_f32_32x32x16_bf16 v[96:111], a[228:231], a[48:51], v[96:111]
    ds_read_b64_tr_b16 a[236:237], v16 offset:30720
    ds_read_b64_tr_b16 a[238:239], v16 offset:31232
    buffer_load_dwordx4 v11, s[20:23], s75 offen offset:3072 lds
    v_mfma_f32_32x32x16_bf16 v[112:127], a[228:231], a[52:55], v[112:127]
    s_waitcnt vmcnt(8)
    s_barrier
    s_waitcnt lgkmcnt(3)
    v_mfma_f32_32x32x16_bf16 v[64:79], a[232:235], a[56:59], v[64:79]
    ds_read_b64_tr_b16 a[224:225], v16 offset:32768
    ds_read_b64_tr_b16 a[226:227], v16 offset:33280
    ds_read_b128 a[64:67], v20 offset:32768
    s_add_u32 m0, s10, 65536
    s_add_u32 s74, s8, s96
    buffer_load_dwordx4 v4, s[12:15], s74 offen lds
    s_waitcnt lgkmcnt(5)
    v_mfma_f32_32x32x16_bf16 v[80:95], a[232:235], a[60:63], v[80:95]
    ds_read_b128 a[68:71], v20 offset:36864
    s_waitcnt lgkmcnt(4)
    v_mfma_f32_32x32x16_bf16 v[96:111], a[236:239], a[56:59], v[96:111]
    ds_read_b64_tr_b16 a[228:229], v16 offset:40960
    ds_read_b64_tr_b16 a[230:231], v16 offset:41472
    buffer_load_dwordx4 v5, s[12:15], s74 offen offset:1024 lds
    v_mfma_f32_32x32x16_bf16 v[112:127], a[236:239], a[60:63], v[112:127]
    s_waitcnt lgkmcnt(3)
    v_mfma_f32_32x32x16_bf16 v[64:79], a[224:227], a[64:67], v[64:79]
    ds_read_b64_tr_b16 a[232:233], v16 offset:34816
    ds_read_b64_tr_b16 a[234:235], v16 offset:35328
    ds_read_b128 a[72:75], v21 offset:32768
    buffer_load_dwordx4 v6, s[12:15], s74 offen offset:2048 lds
    s_waitcnt lgkmcnt(5)
    v_mfma_f32_32x32x16_bf16 v[80:95], a[224:227], a[68:71], v[80:95]
    ds_read_b128 a[76:79], v21 offset:36864
    s_waitcnt lgkmcnt(4)
    v_mfma_f32_32x32x16_bf16 v[96:111], a[228:231], a[64:67], v[96:111]
    ds_read_b64_tr_b16 a[236:237], v16 offset:43008
    ds_read_b64_tr_b16 a[238:239], v16 offset:43520
    buffer_load_dwordx4 v7, s[12:15], s74 offen offset:3072 lds
    v_mfma_f32_32x32x16_bf16 v[112:127], a[228:231], a[68:71], v[112:127]
    s_waitcnt lgkmcnt(3)
    v_mfma_f32_32x32x16_bf16 v[64:79], a[232:235], a[72:75], v[64:79]
    ds_read_b64_tr_b16 a[224:225], v16 offset:36864
    ds_read_b64_tr_b16 a[226:227], v16 offset:37376
    ds_read_b128 a[80:83], v22 offset:32768
    s_add_u32 m0, s11, 65536
    s_mul_i32 s75, s96, 1792
    s_add_u32 s75, s75, s9
    buffer_load_dwordx4 v8, s[20:23], s75 offen lds
    s_waitcnt lgkmcnt(5)
    v_mfma_f32_32x32x16_bf16 v[80:95], a[232:235], a[76:79], v[80:95]
    ds_read_b128 a[84:87], v22 offset:36864
    s_waitcnt lgkmcnt(4)
    v_mfma_f32_32x32x16_bf16 v[96:111], a[236:239], a[72:75], v[96:111]
    ds_read_b64_tr_b16 a[228:229], v16 offset:45056
    ds_read_b64_tr_b16 a[230:231], v16 offset:45568
    buffer_load_dwordx4 v9, s[20:23], s75 offen offset:1024 lds
    v_mfma_f32_32x32x16_bf16 v[112:127], a[236:239], a[76:79], v[112:127]
    s_waitcnt lgkmcnt(3)
    v_mfma_f32_32x32x16_bf16 v[64:79], a[224:227], a[80:83], v[64:79]
    ds_read_b64_tr_b16 a[232:233], v16 offset:38912
    ds_read_b64_tr_b16 a[234:235], v16 offset:39424
    ds_read_b128 a[88:91], v23 offset:32768
    buffer_load_dwordx4 v10, s[20:23], s75 offen offset:2048 lds
    s_waitcnt lgkmcnt(5)
    v_mfma_f32_32x32x16_bf16 v[80:95], a[224:227], a[84:87], v[80:95]
    ds_read_b128 a[92:95], v23 offset:36864
    s_waitcnt lgkmcnt(4)
    v_mfma_f32_32x32x16_bf16 v[96:111], a[228:231], a[80:83], v[96:111]
    ds_read_b64_tr_b16 a[236:237], v16 offset:47104
    ds_read_b64_tr_b16 a[238:239], v16 offset:47616
    buffer_load_dwordx4 v11, s[20:23], s75 offen offset:3072 lds
    v_mfma_f32_32x32x16_bf16 v[112:127], a[228:231], a[84:87], v[112:127]
    s_waitcnt vmcnt(8)
    s_barrier
    s_waitcnt lgkmcnt(3)
    v_mfma_f32_32x32x16_bf16 v[64:79], a[232:235], a[88:91], v[64:79]
    ds_read_b64_tr_b16 a[224:225], v16 offset:49152
    ds_read_b64_tr_b16 a[226:227], v16 offset:49664
    ds_read_b128 a[96:99], v20 offset:49152
    s_add_u32 m0, s10, 0
    s_add_u32 s74, s8, s97
    buffer_load_dwordx4 v4, s[12:15], s74 offen lds
    s_waitcnt lgkmcnt(5)
    v_mfma_f32_32x32x16_bf16 v[80:95], a[232:235], a[92:95], v[80:95]
    ds_read_b128 a[100:103], v20 offset:53248
    s_waitcnt lgkmcnt(4)
    v_mfma_f32_32x32x16_bf16 v[96:111], a[236:239], a[88:91], v[96:111]
    ds_read_b64_tr_b16 a[228:229], v16 offset:57344
    ds_read_b64_tr_b16 a[230:231], v16 offset:57856
    buffer_load_dwordx4 v5, s[12:15], s74 offen offset:1024 lds
    v_mfma_f32_32x32x16_bf16 v[112:127], a[236:239], a[92:95], v[112:127]
    s_waitcnt lgkmcnt(3)
    v_mfma_f32_32x32x16_bf16 v[64:79], a[224:227], a[96:99], v[64:79]
    ds_read_b64_tr_b16 a[232:233], v16 offset:51200
    ds_read_b64_tr_b16 a[234:235], v16 offset:51712
    ds_read_b128 a[104:107], v21 offset:49152
    buffer_load_dwordx4 v6, s[12:15], s74 offen offset:2048 lds
    s_waitcnt lgkmcnt(5)
    v_mfma_f32_32x32x16_bf16 v[80:95], a[224:227], a[100:103], v[80:95]
    ds_read_b128 a[108:111], v21 offset:53248
    s_waitcnt lgkmcnt(4)
    v_mfma_f32_32x32x16_bf16 v[96:111], a[228:231], a[96:99], v[96:111]
    ds_read_b64_tr_b16 a[236:237], v16 offset:59392
    ds_read_b64_tr_b16 a[238:239], v16 offset:59904
    buffer_load_dwordx4 v7, s[12:15], s74 offen offset:3072 lds
    v_mfma_f32_32x32x16_bf16 v[112:127], a[228:231], a[100:103], v[112:127]
    s_waitcnt lgkmcnt(3)
    v_mfma_f32_32x32x16_bf16 v[64:79], a[232:235], a[104:107], v[64:79]
    ds_read_b64_tr_b16 a[224:225], v16 offset:53248
    ds_read_b64_tr_b16 a[226:227], v16 offset:53760
    ds_read_b128 a[112:115], v22 offset:49152
    s_add_u32 m0, s11, 0
    s_mul_i32 s75, s97, 1792
    s_add_u32 s75, s75, s9
    buffer_load_dwordx4 v8, s[20:23], s75 offen lds
    s_waitcnt lgkmcnt(5)
    v_mfma_f32_32x32x16_bf16 v[80:95], a[232:235], a[108:111], v[80:95]
    ds_read_b128 a[116:119], v22 offset:53248
    s_waitcnt lgkmcnt(4)
    v_mfma_f32_32x32x16_bf16 v[96:111], a[236:239], a[104:107], v[96:111]
    ds_read_b64_tr_b16 a[228:229], v16 offset:61440
    ds_read_b64_tr_b16 a[230:231], v16 offset:61952
    buffer_load_dwordx4 v9, s[20:23], s75 offen offset:1024 lds
    v_mfma_f32_32x32x16_bf16 v[112:127], a[236:239], a[108:111], v[112:127]
    s_waitcnt lgkmcnt(3)
    v_mfma_f32_32x32x16_bf16 v[64:79], a[224:227], a[112:115], v[64:79]
    ds_read_b64_tr_b16 a[232:233], v16 offset:55296
    ds_read_b64_tr_b16 a[234:235], v16 offset:55808
    ds_read_b128 a[120:123], v23 offset:49152
    buffer_load_dwordx4 v10, s[20:23], s75 offen offset:2048 lds
    s_waitcnt lgkmcnt(5)
    v_mfma_f32_32x32x16_bf16 v[80:95], a[224:227], a[116:119], v[80:95]
    ds_read_b128 a[124:127], v23 offset:53248
    s_waitcnt lgkmcnt(4)
    v_mfma_f32_32x32x16_bf16 v[96:111], a[228:231], a[112:115], v[96:111]
    ds_read_b64_tr_b16 a[236:237], v16 offset:63488
    ds_read_b64_tr_b16 a[238:239], v16 offset:64000
    buffer_load_dwordx4 v11, s[20:23], s75 offen offset:3072 lds
    v_mfma_f32_32x32x16_bf16 v[112:127], a[228:231], a[116:119], v[112:127]
    s_waitcnt vmcnt(8)
    s_barrier
    s_waitcnt lgkmcnt(3)
    v_mfma_f32_32x32x16_bf16 v[64:79], a[232:235], a[120:123], v[64:79]
    ds_read_b64_tr_b16 a[224:225], v12 offset:0
    ds_read_b64_tr_b16 a[226:227], v12 offset:512
    ds_read_b128 a[128:131], v24 offset:0
    s_add_u32 m0, s10, 16384
    s_add_u32 s74, s8, s98
    buffer_load_dwordx4 v4, s[12:15], s74 offen lds
    s_add_u32 m0, s11, 32768
    s_mul_i32 s75, s92, 1792
    s_add_u32 s75, s75, s61
    buffer_load_dwordx4 v8, s[20:23], s75 offen lds
    s_waitcnt lgkmcnt(5)
    v_mfma_f32_32x32x16_bf16 v[80:95], a[232:235], a[124:127], v[80:95]
    ds_read_b128 a[132:135], v24 offset:4096
    s_waitcnt lgkmcnt(4)
    v_mfma_f32_32x32x16_bf16 v[96:111], a[236:239], a[120:123], v[96:111]
    ds_read_b64_tr_b16 a[228:229], v12 offset:8192
    ds_read_b64_tr_b16 a[230:231], v12 offset:8704
    s_add_u32 m0, s10, 16384
    s_nop 0
    buffer_load_dwordx4 v5, s[12:15], s74 offen offset:1024 lds
    v_mfma_f32_32x32x16_bf16 v[112:127], a[236:239], a[124:127], v[112:127]
    s_waitcnt lgkmcnt(3)
    v_mfma_f32_32x32x16_bf16 v[64:79], a[224:227], a[128:131], v[64:79]
    ds_read_b64_tr_b16 a[232:233], v12 offset:2048
    ds_read_b64_tr_b16 a[234:235], v12 offset:2560
    ds_read_b128 a[136:139], v25 offset:0
    buffer_load_dwordx4 v6, s[12:15], s74 offen offset:2048 lds
    s_add_u32 m0, s11, 32768
    s_nop 0
    buffer_load_dwordx4 v9, s[20:23], s75 offen offset:1024 lds
    s_waitcnt lgkmcnt(5)
    v_mfma_f32_32x32x16_bf16 v[80:95], a[224:227], a[132:135], v[80:95]
    ds_read_b128 a[140:143], v25 offset:4096
    s_waitcnt lgkmcnt(4)
    v_mfma_f32_32x32x16_bf16 v[96:111], a[228:231], a[128:131], v[96:111]
    ds_read_b64_tr_b16 a[236:237], v12 offset:10240
    ds_read_b64_tr_b16 a[238:239], v12 offset:10752
    s_add_u32 m0, s10, 16384
    s_nop 0
    buffer_load_dwordx4 v7, s[12:15], s74 offen offset:3072 lds
    v_mfma_f32_32x32x16_bf16 v[112:127], a[228:231], a[132:135], v[112:127]
    s_waitcnt lgkmcnt(3)
    v_mfma_f32_32x32x16_bf16 v[64:79], a[232:235], a[136:139], v[64:79]
    ds_read_b64_tr_b16 a[224:225], v12 offset:4096
    ds_read_b64_tr_b16 a[226:227], v12 offset:4608
    ds_read_b128 a[144:147], v26 offset:0
    s_add_u32 m0, s11, 16384
    s_mul_i32 s75, s98, 1792
    s_add_u32 s75, s75, s9
    buffer_load_dwordx4 v8, s[20:23], s75 offen lds
    s_add_u32 m0, s11, 32768
    s_mul_i32 s75, s92, 1792
    s_add_u32 s75, s75, s61
    buffer_load_dwordx4 v10, s[20:23], s75 offen offset:2048 lds
    s_waitcnt lgkmcnt(5)
    v_mfma_f32_32x32x16_bf16 v[80:95], a[232:235], a[140:143], v[80:95]
    ds_read_b128 a[148:151], v26 offset:4096
    s_waitcnt lgkmcnt(4)
    v_mfma_f32_32x32x16_bf16 v[96:111], a[236:239], a[136:139], v[96:111]
    ds_read_b64_tr_b16 a[228:229], v12 offset:12288
    ds_read_b64_tr_b16 a[230:231], v12 offset:12800
    s_add_u32 m0, s11, 16384
    s_mul_i32 s75, s98, 1792
    s_add_u32 s75, s75, s9
    buffer_load_dwordx4 v9, s[20:23], s75 offen offset:1024 lds
    v_mfma_f32_32x32x16_bf16 v[112:127], a[236:239], a[140:143], v[112:127]
    s_waitcnt lgkmcnt(3)
    v_mfma_f32_32x32x16_bf16 v[64:79], a[224:227], a[144:147], v[64:79]
    ds_read_b64_tr_b16 a[232:233], v12 offset:6144
    ds_read_b64_tr_b16 a[234:235], v12 offset:6656
    ds_read_b128 a[152:155], v27 offset:0
    buffer_load_dwordx4 v10, s[20:23], s75 offen offset:2048 lds
    s_add_u32 m0, s11, 32768
    s_mul_i32 s75, s92, 1792
    s_add_u32 s75, s75, s61
    buffer_load_dwordx4 v11, s[20:23], s75 offen offset:3072 lds
    s_waitcnt lgkmcnt(5)
    v_mfma_f32_32x32x16_bf16 v[80:95], a[224:227], a[148:151], v[80:95]
    ds_read_b128 a[156:159], v27 offset:4096
    s_waitcnt lgkmcnt(4)
    v_mfma_f32_32x32x16_bf16 v[96:111], a[228:231], a[144:147], v[96:111]
    ds_read_b64_tr_b16 a[236:237], v12 offset:14336
    ds_read_b64_tr_b16 a[238:239], v12 offset:14848
    s_add_u32 m0, s11, 16384
    s_mul_i32 s75, s98, 1792
    s_add_u32 s75, s75, s9
    buffer_load_dwordx4 v11, s[20:23], s75 offen offset:3072 lds
    v_mfma_f32_32x32x16_bf16 v[112:127], a[228:231], a[148:151], v[112:127]
    s_waitcnt vmcnt(12)
    s_barrier
    s_waitcnt lgkmcnt(3)
    v_mfma_f32_32x32x16_bf16 v[64:79], a[232:235], a[152:155], v[64:79]
    ds_read_b64_tr_b16 a[224:225], v16 offset:0
    ds_read_b64_tr_b16 a[226:227], v16 offset:512
    ds_read_b128 a[160:163], v20 offset:0
    s_add_u32 m0, s11, 49152
    s_mul_i32 s75, s93, 1792
    s_add_u32 s75, s75, s61
    buffer_load_dwordx4 v8, s[20:23], s75 offen lds
    s_waitcnt lgkmcnt(5)
    v_mfma_f32_32x32x16_bf16 v[80:95], a[232:235], a[156:159], v[80:95]
    ds_read_b128 a[164:167], v20 offset:4096
    s_waitcnt lgkmcnt(4)
    v_mfma_f32_32x32x16_bf16 v[96:111], a[236:239], a[152:155], v[96:111]
    ds_read_b64_tr_b16 a[228:229], v16 offset:8192
    ds_read_b64_tr_b16 a[230:231], v16 offset:8704
    s_add_u32 m0, s77, 114688
    s_mul_i32 s90, s64, 114688
    s_add_u32 s90, s90, s72
    buffer_load_dwordx4 v30, s[16:19], s90 offen lds
    v_mfma_f32_32x32x16_bf16 v[112:127], a[236:239], a[156:159], v[112:127]
    s_waitcnt lgkmcnt(3)
    v_mfma_f32_32x32x16_bf16 v[64:79], a[224:227], a[160:163], v[64:79]
    ds_read_b64_tr_b16 a[232:233], v16 offset:2048
    ds_read_b64_tr_b16 a[234:235], v16 offset:2560
    ds_read_b128 a[168:171], v21 offset:0
    s_add_u32 m0, s11, 49152
    s_nop 0
    buffer_load_dwordx4 v9, s[20:23], s75 offen offset:1024 lds
    s_waitcnt lgkmcnt(5)
    v_mfma_f32_32x32x16_bf16 v[80:95], a[224:227], a[164:167], v[80:95]
    ds_read_b128 a[172:175], v21 offset:4096
    s_add_u32 m0, s77, 114688
    s_nop 0
    buffer_load_dwordx4 v31, s[16:19], s90 offen offset:1024 lds
    s_waitcnt lgkmcnt(4)
    v_mfma_f32_32x32x16_bf16 v[96:111], a[228:231], a[160:163], v[96:111]
    ds_read_b64_tr_b16 a[236:237], v16 offset:10240
    ds_read_b64_tr_b16 a[238:239], v16 offset:10752
    v_mfma_f32_32x32x16_bf16 v[112:127], a[228:231], a[164:167], v[112:127]
    s_waitcnt lgkmcnt(3)
    v_mfma_f32_32x32x16_bf16 v[64:79], a[232:235], a[168:171], v[64:79]
    ds_read_b64_tr_b16 a[224:225], v16 offset:4096
    ds_read_b64_tr_b16 a[226:227], v16 offset:4608
    ds_read_b128 a[176:179], v22 offset:0
    s_add_u32 m0, s77, 122880
    s_mul_i32 s90, s65, 114688
    s_add_u32 s90, s90, s72
    buffer_load_dwordx4 v30, s[16:19], s90 offen lds
    s_add_u32 m0, s11, 49152
    s_nop 0
    buffer_load_dwordx4 v10, s[20:23], s75 offen offset:2048 lds
    s_waitcnt lgkmcnt(5)
    v_mfma_f32_32x32x16_bf16 v[80:95], a[232:235], a[172:175], v[80:95]
    ds_read_b128 a[180:183], v22 offset:4096
    s_waitcnt lgkmcnt(4)
    v_mfma_f32_32x32x16_bf16 v[96:111], a[236:239], a[168:171], v[96:111]
    ds_read_b64_tr_b16 a[228:229], v16 offset:12288
    ds_read_b64_tr_b16 a[230:231], v16 offset:12800
    v_mfma_f32_32x32x16_bf16 v[112:127], a[236:239], a[172:175], v[112:127]
    s_add_u32 m0, s77, 122880
    s_nop 0
    buffer_load_dwordx4 v31, s[16:19], s90 offen offset:1024 lds
    s_waitcnt lgkmcnt(3)
    v_mfma_f32_32x32x16_bf16 v[64:79], a[224:227], a[176:179], v[64:79]
    ds_read_b64_tr_b16 a[232:233], v16 offset:6144
    ds_read_b64_tr_b16 a[234:235], v16 offset:6656
    ds_read_b128 a[184:187], v23 offset:0
    s_add_u32 m0, s11, 49152
    s_nop 0
    buffer_load_dwordx4 v11, s[20:23], s75 offen offset:3072 lds
    s_waitcnt lgkmcnt(5)
    v_mfma_f32_32x32x16_bf16 v[80:95], a[224:227], a[180:183], v[80:95]
    ds_read_b128 a[188:191], v23 offset:4096
    s_waitcnt lgkmcnt(4)
    v_mfma_f32_32x32x16_bf16 v[96:111], a[228:231], a[176:179], v[96:111]
    ds_read_b64_tr_b16 a[236:237], v16 offset:14336
    ds_read_b64_tr_b16 a[238:239], v16 offset:14848
    v_mfma_f32_32x32x16_bf16 v[112:127], a[228:231], a[180:183], v[112:127]
    s_waitcnt vmcnt(8)
    s_barrier
    s_waitcnt lgkmcnt(3)
    v_mfma_f32_32x32x16_bf16 v[64:79], a[232:235], a[184:187], v[64:79]
    ds_read_b64_tr_b16 a[224:225], v16 offset:16384
    ds_read_b64_tr_b16 a[226:227], v16 offset:16896
    ds_read_b128 a[192:195], v20 offset:16384
    s_add_u32 m0, s11, 65536
    s_mul_i32 s75, s94, 1792
    s_add_u32 s75, s75, s61
    buffer_load_dwordx4 v8, s[20:23], s75 offen lds
    s_waitcnt lgkmcnt(5)
    v_mfma_f32_32x32x16_bf16 v[80:95], a[232:235], a[188:191], v[80:95]
    ds_read_b128 a[196:199], v20 offset:20480
    s_waitcnt lgkmcnt(4)
    v_mfma_f32_32x32x16_bf16 v[96:111], a[236:239], a[184:187], v[96:111]
    ds_read_b64_tr_b16 a[228:229], v16 offset:24576
    ds_read_b64_tr_b16 a[230:231], v16 offset:25088
    s_add_u32 m0, s77, 131072
    s_mul_i32 s90, s66, 114688
    s_add_u32 s90, s90, s72
    buffer_load_dwordx4 v30, s[16:19], s90 offen lds
    v_mfma_f32_32x32x16_bf16 v[112:127], a[236:239], a[188:191], v[112:127]
    s_waitcnt lgkmcnt(3)
    v_mfma_f32_32x32x16_bf16 v[64:79], a[224:227], a[192:195], v[64:79]
    ds_read_b64_tr_b16 a[232:233], v16 offset:18432
    ds_read_b64_tr_b16 a[234:235], v16 offset:18944
    ds_read_b128 a[200:203], v21 offset:16384
    s_add_u32 m0, s11, 65536
    s_nop 0
    buffer_load_dwordx4 v9, s[20:23], s75 offen offset:1024 lds
    s_waitcnt lgkmcnt(5)
    v_mfma_f32_32x32x16_bf16 v[80:95], a[224:227], a[196:199], v[80:95]
    ds_read_b128 a[204:207], v21 offset:20480
    s_add_u32 m0, s77, 131072
    s_nop 0
    buffer_load_dwordx4 v31, s[16:19], s90 offen offset:1024 lds
    s_waitcnt lgkmcnt(4)
    v_mfma_f32_32x32x16_bf16 v[96:111], a[228:231], a[192:195], v[96:111]
    ds_read_b64_tr_b16 a[236:237], v16 offset:26624
    ds_read_b64_tr_b16 a[238:239], v16 offset:27136
    v_mfma_f32_32x32x16_bf16 v[112:127], a[228:231], a[196:199], v[112:127]
    s_waitcnt lgkmcnt(3)
    v_mfma_f32_32x32x16_bf16 v[64:79], a[232:235], a[200:203], v[64:79]
    ds_read_b64_tr_b16 a[224:225], v16 offset:20480
    ds_read_b64_tr_b16 a[226:227], v16 offset:20992
    ds_read_b128 a[208:211], v22 offset:16384
    s_add_u32 m0, s77, 139264
    s_mul_i32 s90, s67, 114688
    s_add_u32 s90, s90, s72
    buffer_load_dwordx4 v30, s[16:19], s90 offen lds
    s_add_u32 m0, s11, 65536
    s_nop 0
    buffer_load_dwordx4 v10, s[20:23], s75 offen offset:2048 lds
    s_waitcnt lgkmcnt(5)
    v_mfma_f32_32x32x16_bf16 v[80:95], a[232:235], a[204:207], v[80:95]
    ds_read_b128 a[212:215], v22 offset:20480
    s_waitcnt lgkmcnt(4)
    v_mfma_f32_32x32x16_bf16 v[96:111], a[236:239], a[200:203], v[96:111]
    ds_read_b64_tr_b16 a[228:229], v16 offset:28672
    ds_read_b64_tr_b16 a[230:231], v16 offset:29184
    v_mfma_f32_32x32x16_bf16 v[112:127], a[236:239], a[204:207], v[112:127]
    s_add_u32 m0, s77, 139264
    s_nop 0
    buffer_load_dwordx4 v31, s[16:19], s90 offen offset:1024 lds
    s_waitcnt lgkmcnt(3)
    v_mfma_f32_32x32x16_bf16 v[64:79], a[224:227], a[208:211], v[64:79]
    ds_read_b64_tr_b16 a[232:233], v16 offset:22528
    ds_read_b64_tr_b16 a[234:235], v16 offset:23040
    ds_read_b128 a[216:219], v23 offset:16384
    s_add_u32 m0, s11, 65536
    s_nop 0
    buffer_load_dwordx4 v11, s[20:23], s75 offen offset:3072 lds
    s_waitcnt lgkmcnt(5)
    v_mfma_f32_32x32x16_bf16 v[80:95], a[224:227], a[212:215], v[80:95]
    ds_read_b128 a[220:223], v23 offset:20480
    s_waitcnt lgkmcnt(4)
    v_mfma_f32_32x32x16_bf16 v[96:111], a[228:231], a[208:211], v[96:111]
    ds_read_b64_tr_b16 a[236:237], v16 offset:30720
    ds_read_b64_tr_b16 a[238:239], v16 offset:31232
    s_add_u32 m0, s77, 147456
    s_mul_i32 s90, s68, 114688
    s_add_u32 s90, s90, s72
    buffer_load_dwordx4 v30, s[16:19], s90 offen lds
    v_mfma_f32_32x32x16_bf16 v[112:127], a[228:231], a[212:215], v[112:127]
    s_barrier
    s_waitcnt lgkmcnt(3)
    v_mfma_f32_32x32x16_bf16 v[64:79], a[232:235], a[216:219], v[64:79]
    ds_read_b64_tr_b16 a[224:225], v16 offset:32768
    ds_read_b64_tr_b16 a[226:227], v16 offset:33280
    s_add_u32 m0, s11, 0
    s_mul_i32 s75, s95, 1792
    s_add_u32 s75, s75, s61
    buffer_load_dwordx4 v8, s[20:23], s75 offen lds
    s_waitcnt lgkmcnt(4)
    v_mfma_f32_32x32x16_bf16 v[80:95], a[232:235], a[220:223], v[80:95]
    s_add_u32 m0, s77, 147456
    s_nop 0
    buffer_load_dwordx4 v31, s[16:19], s90 offen offset:1024 lds
    s_waitcnt lgkmcnt(2)
    v_mfma_f32_32x32x16_bf16 v[96:111], a[236:239], a[216:219], v[96:111]
    ds_read_b64_tr_b16 a[228:229], v16 offset:40960
    ds_read_b64_tr_b16 a[230:231], v16 offset:41472
    v_mfma_f32_32x32x16_bf16 v[112:127], a[236:239], a[220:223], v[112:127]
    s_waitcnt lgkmcnt(2)
    v_mfma_f32_32x32x16_bf16 v[128:143], a[224:227], a[0:3], 0
    ds_read_b64_tr_b16 a[232:233], v16 offset:34816
    ds_read_b64_tr_b16 a[234:235], v16 offset:35328
    s_add_u32 m0, s77, 155648
    s_mul_i32 s90, s69, 114688
    s_add_u32 s90, s90, s72
    buffer_load_dwordx4 v30, s[16:19], s90 offen lds
    s_add_u32 m0, s11, 0
    s_nop 0
    buffer_load_dwordx4 v9, s[20:23], s75 offen offset:1024 lds
    v_mfma_f32_32x32x16_bf16 v[144:159], a[224:227], a[4:7], 0
    s_waitcnt lgkmcnt(2)
    v_mfma_f32_32x32x16_bf16 v[160:175], a[228:231], a[0:3], 0
    ds_read_b64_tr_b16 a[236:237], v16 offset:43008
    ds_read_b64_tr_b16 a[238:239], v16 offset:43520
    v_mfma_f32_32x32x16_bf16 v[176:191], a[228:231], a[4:7], 0
    s_add_u32 m0, s77, 155648
    s_nop 0
    buffer_load_dwordx4 v31, s[16:19], s90 offen offset:1024 lds
    s_waitcnt lgkmcnt(2)
    v_mfma_f32_32x32x16_bf16 v[128:143], a[232:235], a[8:11], v[128:143]
    ds_read_b64_tr_b16 a[224:225], v16 offset:36864
    ds_read_b64_tr_b16 a[226:227], v16 offset:37376
    v_mul_f32 v192, s54, v64
    v_mul_f32 v193, s54, v65
    v_mul_f32 v194, s54, v66
    v_mul_f32 v195, s54, v67
    v_exp_f32 v192, v192
    v_exp_f32 v193, v193
    v_exp_f32 v194, v194
    v_exp_f32 v195, v195
    v_add_f32 v192, 1.0, v192
    v_add_f32 v193, 1.0, v193
    v_add_f32 v194, 1.0, v194
    v_add_f32 v195, 1.0, v195
    s_add_u32 m0, s11, 0
    s_nop 0
    buffer_load_dwordx4 v10, s[20:23], s75 offen offset:2048 lds
    v_mfma_f32_32x32x16_bf16 v[144:159], a[232:235], a[12:15], v[144:159]
    v_rcp_f32 v192, v192
    v_rcp_f32 v193, v193
    v_rcp_f32 v194, v194
    v_rcp_f32 v195, v195
    v_mul_f32 v192, v192, v96
    v_mul_f32 v193, v193, v97
    v_mul_f32 v194, v194, v98
    v_mul_f32 v195, v195, v99
    v_cvt_pk_bf16_f32 v240, v192, v193
    v_cvt_pk_bf16_f32 v241, v194, v195
    v_mul_f32 v196, s54, v68
    s_waitcnt lgkmcnt(2)
    v_mfma_f32_32x32x16_bf16 v[160:175], a[236:239], a[8:11], v[160:175]
    ds_read_b64_tr_b16 a[228:229], v16 offset:45056
    ds_read_b64_tr_b16 a[230:231], v16 offset:45568
    v_mul_f32 v197, s54, v69
    v_mul_f32 v198, s54, v70
    v_mul_f32 v199, s54, v71
    v_exp_f32 v196, v196
    v_exp_f32 v197, v197
    v_exp_f32 v198, v198
    v_exp_f32 v199, v199
    v_add_f32 v196, 1.0, v196
    v_add_f32 v197, 1.0, v197
    v_add_f32 v198, 1.0, v198
    v_add_f32 v199, 1.0, v199
    v_mfma_f32_32x32x16_bf16 v[176:191], a[236:239], a[12:15], v[176:191]
    v_rcp_f32 v196, v196
    v_rcp_f32 v197, v197
    v_rcp_f32 v198, v198
    v_rcp_f32 v199, v199
    v_mul_f32 v196, v196, v100
    v_mul_f32 v197, v197, v101
    v_mul_f32 v198, v198, v102
    v_mul_f32 v199, v199, v103
    v_cvt_pk_bf16_f32 v242, v196, v197
    v_cvt_pk_bf16_f32 v243, v198, v199
    buffer_store_dwordx4 v[240:243], v28, s[24:27], s52 offen sc1
    s_waitcnt lgkmcnt(2)
    v_mfma_f32_32x32x16_bf16 v[128:143], a[224:227], a[16:19], v[128:143]
    ds_read_b64_tr_b16 a[232:233], v16 offset:38912
    ds_read_b64_tr_b16 a[234:235], v16 offset:39424
    v_mul_f32 v200, s54, v72
    v_mul_f32 v201, s54, v73
    v_mul_f32 v202, s54, v74
    v_mul_f32 v203, s54, v75
    v_exp_f32 v200, v200
    v_exp_f32 v201, v201
    v_exp_f32 v202, v202
    v_exp_f32 v203, v203
    v_add_f32 v200, 1.0, v200
    v_add_f32 v201, 1.0, v201
    v_add_f32 v202, 1.0, v202
    v_add_f32 v203, 1.0, v203
    buffer_load_dwordx4 v11, s[20:23], s75 offen offset:3072 lds
    v_mfma_f32_32x32x16_bf16 v[144:159], a[224:227], a[20:23], v[144:159]
    v_rcp_f32 v200, v200
    v_rcp_f32 v201, v201
    v_rcp_f32 v202, v202
    v_rcp_f32 v203, v203
    v_mul_f32 v200, v200, v104
    v_mul_f32 v201, v201, v105
    v_mul_f32 v202, v202, v106
    v_mul_f32 v203, v203, v107
    v_cvt_pk_bf16_f32 v244, v200, v201
    v_cvt_pk_bf16_f32 v245, v202, v203
    v_mul_f32 v204, s54, v76
    s_waitcnt lgkmcnt(2)
    v_mfma_f32_32x32x16_bf16 v[160:175], a[228:231], a[16:19], v[160:175]
    ds_read_b64_tr_b16 a[236:237], v16 offset:47104
    ds_read_b64_tr_b16 a[238:239], v16 offset:47616
    v_mul_f32 v205, s54, v77
    v_mul_f32 v206, s54, v78
    v_mul_f32 v207, s54, v79
    v_exp_f32 v204, v204
    v_exp_f32 v205, v205
    v_exp_f32 v206, v206
    v_exp_f32 v207, v207
    v_add_f32 v204, 1.0, v204
    v_add_f32 v205, 1.0, v205
    v_add_f32 v206, 1.0, v206
    v_add_f32 v207, 1.0, v207
    v_mfma_f32_32x32x16_bf16 v[176:191], a[228:231], a[20:23], v[176:191]
    v_rcp_f32 v204, v204
    v_rcp_f32 v205, v205
    v_rcp_f32 v206, v206
    v_rcp_f32 v207, v207
    v_mul_f32 v204, v204, v108
    v_mul_f32 v205, v205, v109
    v_mul_f32 v206, v206, v110
    v_mul_f32 v207, v207, v111
    v_cvt_pk_bf16_f32 v246, v204, v205
    v_cvt_pk_bf16_f32 v247, v206, v207
    buffer_store_dwordx4 v[244:247], v28, s[24:27], s52 offen offset:1024 sc1
    s_waitcnt vmcnt(18)
    s_barrier
    s_waitcnt lgkmcnt(2)
    v_mfma_f32_32x32x16_bf16 v[128:143], a[232:235], a[24:27], v[128:143]
    ds_read_b64_tr_b16 a[224:225], v16 offset:49152
    ds_read_b64_tr_b16 a[226:227], v16 offset:49664
    v_mul_f32 v208, s54, v80
    v_mul_f32 v209, s54, v81
    v_mul_f32 v210, s54, v82
    v_mul_f32 v211, s54, v83
    v_exp_f32 v208, v208
    v_exp_f32 v209, v209
    v_exp_f32 v210, v210
    v_exp_f32 v211, v211
    v_add_f32 v208, 1.0, v208
    v_add_f32 v209, 1.0, v209
    v_add_f32 v210, 1.0, v210
    v_add_f32 v211, 1.0, v211
    s_add_u32 m0, s11, 16384
    s_mul_i32 s75, s96, 1792
    s_add_u32 s75, s75, s61
    buffer_load_dwordx4 v8, s[20:23], s75 offen lds
    v_mfma_f32_32x32x16_bf16 v[144:159], a[232:235], a[28:31], v[144:159]
    v_rcp_f32 v208, v208
    v_rcp_f32 v209, v209
    v_rcp_f32 v210, v210
    v_rcp_f32 v211, v211
    v_mul_f32 v208, v208, v112
    v_mul_f32 v209, v209, v113
    v_mul_f32 v210, v210, v114
    v_mul_f32 v211, v211, v115
    v_cvt_pk_bf16_f32 v248, v208, v209
    v_cvt_pk_bf16_f32 v249, v210, v211
    v_mul_f32 v212, s54, v84
    s_waitcnt lgkmcnt(2)
    v_mfma_f32_32x32x16_bf16 v[160:175], a[236:239], a[24:27], v[160:175]
    ds_read_b64_tr_b16 a[228:229], v16 offset:57344
    ds_read_b64_tr_b16 a[230:231], v16 offset:57856
    v_mul_f32 v213, s54, v85
    v_mul_f32 v214, s54, v86
    v_mul_f32 v215, s54, v87
    v_exp_f32 v212, v212
    v_exp_f32 v213, v213
    v_exp_f32 v214, v214
    v_exp_f32 v215, v215
    v_add_f32 v212, 1.0, v212
    v_add_f32 v213, 1.0, v213
    v_add_f32 v214, 1.0, v214
    v_add_f32 v215, 1.0, v215
    v_mfma_f32_32x32x16_bf16 v[176:191], a[236:239], a[28:31], v[176:191]
    v_rcp_f32 v212, v212
    v_rcp_f32 v213, v213
    v_rcp_f32 v214, v214
    v_rcp_f32 v215, v215
    v_mul_f32 v212, v212, v116
    v_mul_f32 v213, v213, v117
    v_mul_f32 v214, v214, v118
    v_mul_f32 v215, v215, v119
    v_cvt_pk_bf16_f32 v250, v212, v213
    v_cvt_pk_bf16_f32 v251, v214, v215
    buffer_store_dwordx4 v[248:251], v28, s[24:27], s53 offen sc1
    s_waitcnt lgkmcnt(2)
    v_mfma_f32_32x32x16_bf16 v[128:143], a[224:227], a[32:35], v[128:143]
    ds_read_b64_tr_b16 a[232:233], v16 offset:51200
    ds_read_b64_tr_b16 a[234:235], v16 offset:51712
    v_mul_f32 v216, s54, v88
    v_mul_f32 v217, s54, v89
    v_mul_f32 v218, s54, v90
    v_mul_f32 v219, s54, v91
    v_exp_f32 v216, v216
    v_exp_f32 v217, v217
    v_exp_f32 v218, v218
    v_exp_f32 v219, v219
    v_add_f32 v216, 1.0, v216
    v_add_f32 v217, 1.0, v217
    v_add_f32 v218, 1.0, v218
    v_add_f32 v219, 1.0, v219
    buffer_load_dwordx4 v9, s[20:23], s75 offen offset:1024 lds
    v_mfma_f32_32x32x16_bf16 v[144:159], a[224:227], a[36:39], v[144:159]
    v_rcp_f32 v216, v216
    v_rcp_f32 v217, v217
    v_rcp_f32 v218, v218
    v_rcp_f32 v219, v219
    v_mul_f32 v216, v216, v120
    v_mul_f32 v217, v217, v121
    v_mul_f32 v218, v218, v122
    v_mul_f32 v219, v219, v123
    v_cvt_pk_bf16_f32 v252, v216, v217
    v_cvt_pk_bf16_f32 v253, v218, v219
    v_mul_f32 v220, s54, v92
    s_waitcnt lgkmcnt(2)
    v_mfma_f32_32x32x16_bf16 v[160:175], a[228:231], a[32:35], v[160:175]
    ds_read_b64_tr_b16 a[236:237], v16 offset:59392
    ds_read_b64_tr_b16 a[238:239], v16 offset:59904
    v_mul_f32 v221, s54, v93
    v_mul_f32 v222, s54, v94
    v_mul_f32 v223, s54, v95
    v_exp_f32 v220, v220
    v_exp_f32 v221, v221
    v_exp_f32 v222, v222
    v_exp_f32 v223, v223
    v_add_f32 v220, 1.0, v220
    v_add_f32 v221, 1.0, v221
    v_add_f32 v222, 1.0, v222
    v_add_f32 v223, 1.0, v223
    v_mfma_f32_32x32x16_bf16 v[176:191], a[228:231], a[36:39], v[176:191]
    v_rcp_f32 v220, v220
    v_rcp_f32 v221, v221
    v_rcp_f32 v222, v222
    v_rcp_f32 v223, v223
    v_mul_f32 v220, v220, v124
    v_mul_f32 v221, v221, v125
    v_mul_f32 v222, v222, v126
    v_mul_f32 v223, v223, v127
    v_cvt_pk_bf16_f32 v254, v220, v221
    v_cvt_pk_bf16_f32 v255, v222, v223
    buffer_store_dwordx4 v[252:255], v28, s[24:27], s53 offen offset:1024 sc1
    s_waitcnt lgkmcnt(2)
    v_mfma_f32_32x32x16_bf16 v[128:143], a[232:235], a[40:43], v[128:143]
    ds_read_b64_tr_b16 a[224:225], v16 offset:53248
    ds_read_b64_tr_b16 a[226:227], v16 offset:53760
    buffer_load_dwordx4 v10, s[20:23], s75 offen offset:2048 lds
    v_mfma_f32_32x32x16_bf16 v[144:159], a[232:235], a[44:47], v[144:159]
    s_waitcnt lgkmcnt(2)
    v_mfma_f32_32x32x16_bf16 v[160:175], a[236:239], a[40:43], v[160:175]
    ds_read_b64_tr_b16 a[228:229], v16 offset:61440
    ds_read_b64_tr_b16 a[230:231], v16 offset:61952
    v_mfma_f32_32x32x16_bf16 v[176:191], a[236:239], a[44:47], v[176:191]
    s_waitcnt lgkmcnt(2)
    v_mfma_f32_32x32x16_bf16 v[128:143], a[224:227], a[48:51], v[128:143]
    ds_read_b64_tr_b16 a[232:233], v16 offset:55296
    ds_read_b64_tr_b16 a[234:235], v16 offset:55808
    buffer_load_dwordx4 v11, s[20:23], s75 offen offset:3072 lds
    v_mfma_f32_32x32x16_bf16 v[144:159], a[224:227], a[52:55], v[144:159]
    s_waitcnt lgkmcnt(2)
    v_mfma_f32_32x32x16_bf16 v[160:175], a[228:231], a[48:51], v[160:175]
    ds_read_b64_tr_b16 a[236:237], v16 offset:63488
    ds_read_b64_tr_b16 a[238:239], v16 offset:64000
    v_mfma_f32_32x32x16_bf16 v[176:191], a[228:231], a[52:55], v[176:191]
    s_waitcnt vmcnt(16)
    s_barrier
    s_waitcnt lgkmcnt(2)
    v_mfma_f32_32x32x16_bf16 v[128:143], a[232:235], a[56:59], v[128:143]
    ds_read_b64_tr_b16 a[224:225], v12 offset:0
    ds_read_b64_tr_b16 a[226:227], v12 offset:512
    s_add_u32 m0, s11, 32768
    s_mul_i32 s75, s97, 1792
    s_add_u32 s75, s75, s61
    buffer_load_dwordx4 v8, s[20:23], s75 offen lds
    v_mfma_f32_32x32x16_bf16 v[144:159], a[232:235], a[60:63], v[144:159]
    s_waitcnt lgkmcnt(2)
    v_mfma_f32_32x32x16_bf16 v[160:175], a[236:239], a[56:59], v[160:175]
    ds_read_b64_tr_b16 a[228:229], v12 offset:8192
    ds_read_b64_tr_b16 a[230:231], v12 offset:8704
    v_mfma_f32_32x32x16_bf16 v[176:191], a[236:239], a[60:63], v[176:191]
    s_waitcnt lgkmcnt(2)
    v_mfma_f32_32x32x16_bf16 v[128:143], a[224:227], a[64:67], v[128:143]
    ds_read_b64_tr_b16 a[232:233], v12 offset:2048
    ds_read_b64_tr_b16 a[234:235], v12 offset:2560
    buffer_load_dwordx4 v9, s[20:23], s75 offen offset:1024 lds
    v_mfma_f32_32x32x16_bf16 v[144:159], a[224:227], a[68:71], v[144:159]
    s_waitcnt lgkmcnt(2)
    v_mfma_f32_32x32x16_bf16 v[160:175], a[228:231], a[64:67], v[160:175]
    ds_read_b64_tr_b16 a[236:237], v12 offset:10240
    ds_read_b64_tr_b16 a[238:239], v12 offset:10752
    s_waitcnt vmcnt(4)
    buffer_store_dword v61, off, s[44:47], s56 offset:0 sc1
    v_mfma_f32_32x32x16_bf16 v[176:191], a[228:231], a[68:71], v[176:191]
    s_waitcnt lgkmcnt(2)
    v_mfma_f32_32x32x16_bf16 v[128:143], a[232:235], a[72:75], v[128:143]
    ds_read_b64_tr_b16 a[224:225], v12 offset:4096
    ds_read_b64_tr_b16 a[226:227], v12 offset:4608
    buffer_load_dwordx4 v10, s[20:23], s75 offen offset:2048 lds
    v_mfma_f32_32x32x16_bf16 v[144:159], a[232:235], a[76:79], v[144:159]
    s_waitcnt lgkmcnt(2)
    v_mfma_f32_32x32x16_bf16 v[160:175], a[236:239], a[72:75], v[160:175]
    ds_read_b64_tr_b16 a[228:229], v12 offset:12288
    ds_read_b64_tr_b16 a[230:231], v12 offset:12800
    s_add_u32 m0, s77, 81920
    s_mul_i32 s90, s70, 114688
    s_add_u32 s90, s90, s72
    buffer_load_dwordx4 v30, s[16:19], s90 offen lds
    v_mfma_f32_32x32x16_bf16 v[176:191], a[236:239], a[76:79], v[176:191]
    s_waitcnt lgkmcnt(2)
    v_mfma_f32_32x32x16_bf16 v[128:143], a[224:227], a[80:83], v[128:143]
    ds_read_b64_tr_b16 a[232:233], v12 offset:6144
    ds_read_b64_tr_b16 a[234:235], v12 offset:6656
    s_add_u32 m0, s11, 32768
    s_nop 0
    buffer_load_dwordx4 v11, s[20:23], s75 offen offset:3072 lds
    v_mfma_f32_32x32x16_bf16 v[144:159], a[224:227], a[84:87], v[144:159]
    s_add_u32 m0, s77, 81920
    s_nop 0
    buffer_load_dwordx4 v31, s[16:19], s90 offen offset:1024 lds
    s_waitcnt lgkmcnt(2)
    v_mfma_f32_32x32x16_bf16 v[160:175], a[228:231], a[80:83], v[160:175]
    ds_read_b64_tr_b16 a[236:237], v12 offset:14336
    ds_read_b64_tr_b16 a[238:239], v12 offset:14848
    v_mfma_f32_32x32x16_bf16 v[176:191], a[228:231], a[84:87], v[176:191]
    s_barrier
    s_waitcnt lgkmcnt(2)
    v_mfma_f32_32x32x16_bf16 v[128:143], a[232:235], a[88:91], v[128:143]
    ds_read_b64_tr_b16 a[224:225], v16 offset:0
    ds_read_b64_tr_b16 a[226:227], v16 offset:512
    s_add_u32 m0, s77, 90112
    s_mul_i32 s90, s64, 114688
    s_add_u32 s90, s90, s73
    buffer_load_dwordx4 v30, s[16:19], s90 offen lds
    s_add_u32 m0, s11, 49152
    s_mul_i32 s75, s98, 1792
    s_add_u32 s75, s75, s61
    buffer_load_dwordx4 v8, s[20:23], s75 offen lds
    v_mfma_f32_32x32x16_bf16 v[144:159], a[232:235], a[92:95], v[144:159]
    s_waitcnt lgkmcnt(2)
    v_mfma_f32_32x32x16_bf16 v[160:175], a[236:239], a[88:91], v[160:175]
    ds_read_b64_tr_b16 a[228:229], v16 offset:8192
    ds_read_b64_tr_b16 a[230:231], v16 offset:8704
    v_mfma_f32_32x32x16_bf16 v[176:191], a[236:239], a[92:95], v[176:191]
    s_add_u32 m0, s77, 90112
    s_nop 0
    buffer_load_dwordx4 v31, s[16:19], s90 offen offset:1024 lds
    s_waitcnt lgkmcnt(2)
    v_mfma_f32_32x32x16_bf16 v[128:143], a[224:227], a[96:99], v[128:143]
    ds_read_b64_tr_b16 a[232:233], v16 offset:2048
    ds_read_b64_tr_b16 a[234:235], v16 offset:2560
    s_add_u32 m0, s11, 49152
    s_nop 0
    buffer_load_dwordx4 v9, s[20:23], s75 offen offset:1024 lds
    v_mfma_f32_32x32x16_bf16 v[144:159], a[224:227], a[100:103], v[144:159]
    s_waitcnt lgkmcnt(2)
    v_mfma_f32_32x32x16_bf16 v[160:175], a[228:231], a[96:99], v[160:175]
    ds_read_b64_tr_b16 a[236:237], v16 offset:10240
    ds_read_b64_tr_b16 a[238:239], v16 offset:10752
    s_add_u32 m0, s77, 98304
    s_mul_i32 s90, s65, 114688
    s_add_u32 s90, s90, s73
    buffer_load_dwordx4 v30, s[16:19], s90 offen lds
    v_mfma_f32_32x32x16_bf16 v[176:191], a[228:231], a[100:103], v[176:191]
    s_waitcnt lgkmcnt(2)
    v_mfma_f32_32x32x16_bf16 v[128:143], a[232:235], a[104:107], v[128:143]
    ds_read_b64_tr_b16 a[224:225], v16 offset:4096
    ds_read_b64_tr_b16 a[226:227], v16 offset:4608
    s_add_u32 m0, s11, 49152
    s_nop 0
    buffer_load_dwordx4 v10, s[20:23], s75 offen offset:2048 lds
    v_mfma_f32_32x32x16_bf16 v[144:159], a[232:235], a[108:111], v[144:159]
    s_add_u32 m0, s77, 98304
    s_nop 0
    buffer_load_dwordx4 v31, s[16:19], s90 offen offset:1024 lds
    s_waitcnt lgkmcnt(2)
    v_mfma_f32_32x32x16_bf16 v[160:175], a[236:239], a[104:107], v[160:175]
    ds_read_b64_tr_b16 a[228:229], v16 offset:12288
    ds_read_b64_tr_b16 a[230:231], v16 offset:12800
    v_mfma_f32_32x32x16_bf16 v[176:191], a[236:239], a[108:111], v[176:191]
    s_waitcnt lgkmcnt(2)
    v_mfma_f32_32x32x16_bf16 v[128:143], a[224:227], a[112:115], v[128:143]
    ds_read_b64_tr_b16 a[232:233], v16 offset:6144
    ds_read_b64_tr_b16 a[234:235], v16 offset:6656
    s_add_u32 m0, s77, 106496
    s_mul_i32 s90, s66, 114688
    s_add_u32 s90, s90, s73
    buffer_load_dwordx4 v30, s[16:19], s90 offen lds
    s_add_u32 m0, s11, 49152
    s_nop 0
    buffer_load_dwordx4 v11, s[20:23], s75 offen offset:3072 lds
    v_mfma_f32_32x32x16_bf16 v[144:159], a[224:227], a[116:119], v[144:159]
    s_waitcnt lgkmcnt(2)
    v_mfma_f32_32x32x16_bf16 v[160:175], a[228:231], a[112:115], v[160:175]
    ds_read_b64_tr_b16 a[236:237], v16 offset:14336
    ds_read_b64_tr_b16 a[238:239], v16 offset:14848
    v_mfma_f32_32x32x16_bf16 v[176:191], a[228:231], a[116:119], v[176:191]
    s_add_u32 m0, s77, 106496
    s_nop 0
    buffer_load_dwordx4 v31, s[16:19], s90 offen offset:1024 lds
    s_waitcnt vmcnt(17)
    s_barrier
    s_waitcnt lgkmcnt(2)
    v_mfma_f32_32x32x16_bf16 v[128:143], a[232:235], a[120:123], v[128:143]
    ds_read_b64_tr_b16 a[224:225], v16 offset:16384
    ds_read_b64_tr_b16 a[226:227], v16 offset:16896
    v_mfma_f32_32x32x16_bf16 v[144:159], a[232:235], a[124:127], v[144:159]
    s_waitcnt lgkmcnt(2)
    v_mfma_f32_32x32x16_bf16 v[160:175], a[236:239], a[120:123], v[160:175]
    ds_read_b64_tr_b16 a[228:229], v16 offset:24576
    ds_read_b64_tr_b16 a[230:231], v16 offset:25088
    s_add_u32 m0, s77, 65536
    s_mul_i32 s90, s69, 114688
    s_add_u32 s90, s90, s73
    buffer_load_dwordx4 v30, s[16:19], s90 offen lds
    v_mfma_f32_32x32x16_bf16 v[176:191], a[236:239], a[124:127], v[176:191]
    s_waitcnt lgkmcnt(2)
    v_mfma_f32_32x32x16_bf16 v[128:143], a[224:227], a[128:131], v[128:143]
    ds_read_b64_tr_b16 a[232:233], v16 offset:18432
    ds_read_b64_tr_b16 a[234:235], v16 offset:18944
    v_mfma_f32_32x32x16_bf16 v[144:159], a[224:227], a[132:135], v[144:159]
    buffer_load_dwordx4 v31, s[16:19], s90 offen offset:1024 lds
    s_waitcnt lgkmcnt(2)
    v_mfma_f32_32x32x16_bf16 v[160:175], a[228:231], a[128:131], v[160:175]
    ds_read_b64_tr_b16 a[236:237], v16 offset:26624
    ds_read_b64_tr_b16 a[238:239], v16 offset:27136
    v_mfma_f32_32x32x16_bf16 v[176:191], a[228:231], a[132:135], v[176:191]
    s_waitcnt lgkmcnt(2)
    v_mfma_f32_32x32x16_bf16 v[128:143], a[232:235], a[136:139], v[128:143]
    ds_read_b64_tr_b16 a[224:225], v16 offset:20480
    ds_read_b64_tr_b16 a[226:227], v16 offset:20992
    s_add_u32 m0, s77, 73728
    s_mul_i32 s90, s70, 114688
    s_add_u32 s90, s90, s73
    buffer_load_dwordx4 v30, s[16:19], s90 offen lds
    v_mfma_f32_32x32x16_bf16 v[144:159], a[232:235], a[140:143], v[144:159]
    s_waitcnt lgkmcnt(2)
    v_mfma_f32_32x32x16_bf16 v[160:175], a[236:239], a[136:139], v[160:175]
    ds_read_b64_tr_b16 a[228:229], v16 offset:28672
    ds_read_b64_tr_b16 a[230:231], v16 offset:29184
    v_mfma_f32_32x32x16_bf16 v[176:191], a[236:239], a[140:143], v[176:191]
    buffer_load_dwordx4 v31, s[16:19], s90 offen offset:1024 lds
    s_waitcnt lgkmcnt(2)
    v_mfma_f32_32x32x16_bf16 v[128:143], a[224:227], a[144:147], v[128:143]
    ds_read_b64_tr_b16 a[232:233], v16 offset:22528
    ds_read_b64_tr_b16 a[234:235], v16 offset:23040
    v_mfma_f32_32x32x16_bf16 v[144:159], a[224:227], a[148:151], v[144:159]
    s_waitcnt lgkmcnt(2)
    v_mfma_f32_32x32x16_bf16 v[160:175], a[228:231], a[144:147], v[160:175]
    ds_read_b64_tr_b16 a[236:237], v16 offset:30720
    ds_read_b64_tr_b16 a[238:239], v16 offset:31232
    v_mfma_f32_32x32x16_bf16 v[176:191], a[228:231], a[148:151], v[176:191]
    s_waitcnt vmcnt(15)
    s_barrier
    s_waitcnt lgkmcnt(2)
    v_mfma_f32_32x32x16_bf16 v[128:143], a[232:235], a[152:155], v[128:143]
    ds_read_b64_tr_b16 a[224:225], v16 offset:32768
    ds_read_b64_tr_b16 a[226:227], v16 offset:33280
    v_mfma_f32_32x32x16_bf16 v[144:159], a[232:235], a[156:159], v[144:159]
    s_waitcnt lgkmcnt(2)
    v_mfma_f32_32x32x16_bf16 v[160:175], a[236:239], a[152:155], v[160:175]
    ds_read_b64_tr_b16 a[228:229], v16 offset:40960
    ds_read_b64_tr_b16 a[230:231], v16 offset:41472
    s_add_u32 m0, s77, 0
    s_mul_i32 s90, s67, 114688
    s_add_u32 s90, s90, s73
    buffer_load_dwordx4 v30, s[16:19], s90 offen lds
    v_mfma_f32_32x32x16_bf16 v[176:191], a[236:239], a[156:159], v[176:191]
    s_waitcnt lgkmcnt(2)
    v_mfma_f32_32x32x16_bf16 v[128:143], a[224:227], a[160:163], v[128:143]
    ds_read_b64_tr_b16 a[232:233], v16 offset:34816
    ds_read_b64_tr_b16 a[234:235], v16 offset:35328
    v_mfma_f32_32x32x16_bf16 v[144:159], a[224:227], a[164:167], v[144:159]
    buffer_load_dwordx4 v31, s[16:19], s90 offen offset:1024 lds
    s_waitcnt lgkmcnt(2)
    v_mfma_f32_32x32x16_bf16 v[160:175], a[228:231], a[160:163], v[160:175]
    ds_read_b64_tr_b16 a[236:237], v16 offset:43008
    ds_read_b64_tr_b16 a[238:239], v16 offset:43520
    v_mfma_f32_32x32x16_bf16 v[176:191], a[228:231], a[164:167], v[176:191]
    s_waitcnt lgkmcnt(2)
    v_mfma_f32_32x32x16_bf16 v[128:143], a[232:235], a[168:171], v[128:143]
    ds_read_b64_tr_b16 a[224:225], v16 offset:36864
    ds_read_b64_tr_b16 a[226:227], v16 offset:37376
    s_add_u32 m0, s77, 8192
    s_mul_i32 s90, s68, 114688
    s_add_u32 s90, s90, s73
    buffer_load_dwordx4 v30, s[16:19], s90 offen lds
    v_mfma_f32_32x32x16_bf16 v[144:159], a[232:235], a[172:175], v[144:159]
    s_waitcnt lgkmcnt(2)
    v_mfma_f32_32x32x16_bf16 v[160:175], a[236:239], a[168:171], v[160:175]
    ds_read_b64_tr_b16 a[228:229], v16 offset:45056
    ds_read_b64_tr_b16 a[230:231], v16 offset:45568
    v_mfma_f32_32x32x16_bf16 v[176:191], a[236:239], a[172:175], v[176:191]
    buffer_load_dwordx4 v31, s[16:19], s90 offen offset:1024 lds
    s_waitcnt lgkmcnt(2)
    v_mfma_f32_32x32x16_bf16 v[128:143], a[224:227], a[176:179], v[128:143]
    ds_read_b64_tr_b16 a[232:233], v16 offset:38912
    ds_read_b64_tr_b16 a[234:235], v16 offset:39424
    buffer_load_dword v18, v43, s[44:47], s57 offen offset:0 sc1
    v_mfma_f32_32x32x16_bf16 v[144:159], a[224:227], a[180:183], v[144:159]
    s_waitcnt lgkmcnt(2)
    v_mfma_f32_32x32x16_bf16 v[160:175], a[228:231], a[176:179], v[160:175]
    ds_read_b64_tr_b16 a[236:237], v16 offset:47104
    ds_read_b64_tr_b16 a[238:239], v16 offset:47616
    v_mfma_f32_32x32x16_bf16 v[176:191], a[228:231], a[180:183], v[176:191]
    s_waitcnt vmcnt(10)
    s_barrier
    s_waitcnt lgkmcnt(2)
    v_mfma_f32_32x32x16_bf16 v[128:143], a[232:235], a[184:187], v[128:143]
    ds_read_b64_tr_b16 a[224:225], v16 offset:49152
    ds_read_b64_tr_b16 a[226:227], v16 offset:49664
    v_mfma_f32_32x32x16_bf16 v[144:159], a[232:235], a[188:191], v[144:159]
    s_waitcnt lgkmcnt(2)
    v_mfma_f32_32x32x16_bf16 v[160:175], a[236:239], a[184:187], v[160:175]
    ds_read_b64_tr_b16 a[228:229], v16 offset:57344
    ds_read_b64_tr_b16 a[230:231], v16 offset:57856
    v_mfma_f32_32x32x16_bf16 v[176:191], a[236:239], a[188:191], v[176:191]
    s_waitcnt lgkmcnt(2)
    v_mfma_f32_32x32x16_bf16 v[128:143], a[224:227], a[192:195], v[128:143]
    ds_read_b64_tr_b16 a[232:233], v16 offset:51200
    ds_read_b64_tr_b16 a[234:235], v16 offset:51712
    v_mfma_f32_32x32x16_bf16 v[144:159], a[224:227], a[196:199], v[144:159]
    s_waitcnt lgkmcnt(2)
    v_mfma_f32_32x32x16_bf16 v[160:175], a[228:231], a[192:195], v[160:175]
    ds_read_b64_tr_b16 a[236:237], v16 offset:59392
    ds_read_b64_tr_b16 a[238:239], v16 offset:59904
    v_mfma_f32_32x32x16_bf16 v[176:191], a[228:231], a[196:199], v[176:191]
    s_waitcnt lgkmcnt(2)
    v_mfma_f32_32x32x16_bf16 v[128:143], a[232:235], a[200:203], v[128:143]
    ds_read_b64_tr_b16 a[224:225], v16 offset:53248
    ds_read_b64_tr_b16 a[226:227], v16 offset:53760
    s_waitcnt vmcnt(0)
    v_cmp_eq_u32 vcc, s55, v18
    s_nop 3
    s_and_b32 s5, vcc_lo, 0x3fff
    s_cmp_eq_u32 s5, 0x3fff
    s_cbranch_scc1 L_poll_ok_3
    s_mov_b32 s62, 0x40000
L_poll_lp_4:
    s_sleep 1
    buffer_load_dword v18, v43, s[44:47], s57 offen offset:0 sc1
    s_waitcnt vmcnt(0)
    s_sub_u32 s62, s62, 1
    s_cmp_eq_u32 s62, 0
    s_cbranch_scc1 L_poll_ok_3
    v_cmp_eq_u32 vcc, s55, v18
    s_nop 3
    s_and_b32 s5, vcc_lo, 0x3fff
    s_cmp_eq_u32 s5, 0x3fff
    s_cbranch_scc0 L_poll_lp_4
L_poll_ok_3:
    v_mfma_f32_32x32x16_bf16 v[144:159], a[232:235], a[204:207], v[144:159]
    s_lshl_b32 s91, s64, 13
    s_add_u32 s91, s91, s71
    buffer_load_dwordx4 a[0:3], v28, s[24:27], s91 offen sc1
    s_waitcnt lgkmcnt(2)
    v_mfma_f32_32x32x16_bf16 v[160:175], a[236:239], a[200:203], v[160:175]
    ds_read_b64_tr_b16 a[228:229], v16 offset:61440
    ds_read_b64_tr_b16 a[230:231], v16 offset:61952
    buffer_load_dwordx4 a[4:7], v28, s[24:27], s91 offen offset:1024 sc1
    v_mfma_f32_32x32x16_bf16 v[176:191], a[236:239], a[204:207], v[176:191]
    buffer_load_dwordx4 a[8:11], v28, s[24:27], s91 offen offset:2048 sc1
    s_waitcnt lgkmcnt(2)
    v_mfma_f32_32x32x16_bf16 v[128:143], a[224:227], a[208:211], v[128:143]
    ds_read_b64_tr_b16 a[232:233], v16 offset:55296
    ds_read_b64_tr_b16 a[234:235], v16 offset:55808
    buffer_load_dwordx4 a[12:15], v28, s[24:27], s91 offen offset:3072 sc1
    v_mfma_f32_32x32x16_bf16 v[144:159], a[224:227], a[212:215], v[144:159]
    s_waitcnt lgkmcnt(2)
    v_mfma_f32_32x32x16_bf16 v[160:175], a[228:231], a[208:211], v[160:175]
    ds_read_b64_tr_b16 a[236:237], v16 offset:63488
    ds_read_b64_tr_b16 a[238:239], v16 offset:64000
    s_lshl_b32 s91, s65, 13
    s_add_u32 s91, s91, s71
    buffer_load_dwordx4 a[16:19], v28, s[24:27], s91 offen sc1
    v_mfma_f32_32x32x16_bf16 v[176:191], a[228:231], a[212:215], v[176:191]
    buffer_load_dwordx4 a[20:23], v28, s[24:27], s91 offen offset:1024 sc1
    s_waitcnt lgkmcnt(2)
    v_mfma_f32_32x32x16_bf16 v[128:143], a[232:235], a[216:219], v[128:143]
    buffer_load_dwordx4 a[24:27], v28, s[24:27], s91 offen offset:2048 sc1
    v_mfma_f32_32x32x16_bf16 v[144:159], a[232:235], a[220:223], v[144:159]
    buffer_load_dwordx4 a[28:31], v28, s[24:27], s91 offen offset:3072 sc1
    s_waitcnt lgkmcnt(0)
    v_mfma_f32_32x32x16_bf16 v[160:175], a[236:239], a[216:219], v[160:175]
    v_mfma_f32_32x32x16_bf16 v[176:191], a[236:239], a[220:223], v[176:191]
    s_waitcnt lgkmcnt(0)
    s_barrier
    s_nop 3
    ds_read_b64_tr_b16 a[240:241], v33 offset:49152
    ds_read_b64_tr_b16 a[242:243], v33 offset:50176
    ds_read_b64_tr_b16 a[244:245], v33 offset:51200
    ds_read_b64_tr_b16 a[246:247], v33 offset:52224
    ds_read_b64_tr_b16 a[248:249], v33 offset:53248
    ds_read_b64_tr_b16 a[250:251], v33 offset:54272
    s_waitcnt vmcnt(7)
    s_waitcnt lgkmcnt(4)
    v_mfma_f32_32x32x16_bf16 v[64:79], a[240:243], a[0:3], 0
    ds_read_b64_tr_b16 a[252:253], v33 offset:55296
    ds_read_b64_tr_b16 a[254:255], v33 offset:56320
    s_lshl_b32 s91, s66, 13
    s_add_u32 s91, s91, s71
    buffer_load_dwordx4 a[32:35], v28, s[24:27], s91 offen sc1
    buffer_load_dwordx4 a[36:39], v28, s[24:27], s91 offen offset:1024 sc1
    v_pk_mul_f32 v[192:193], v[128:129], s[84:85]
    v_pk_mul_f32 v[194:195], v[130:131], s[84:85]
    v_exp_f32 v192, v192
    v_exp_f32 v193, v193
    v_exp_f32 v194, v194
    v_exp_f32 v195, v195
    v_pk_add_f32 v[192:193], v[192:193], s[86:87]
    v_pk_add_f32 v[194:195], v[194:195], s[86:87]
    v_rcp_f32 v192, v192
    v_rcp_f32 v193, v193
    v_rcp_f32 v194, v194
    v_rcp_f32 v195, v195
    v_pk_mul_f32 v[192:193], v[192:193], v[160:161]
    v_pk_mul_f32 v[194:195], v[194:195], v[162:163]
    v_cvt_pk_bf16_f32 v224, v192, v193
    v_cvt_pk_bf16_f32 v225, v194, v195
    v_pk_mul_f32 v[196:197], v[132:133], s[84:85]
    v_pk_mul_f32 v[198:199], v[134:135], s[84:85]
    v_exp_f32 v196, v196
    v_exp_f32 v197, v197
    v_exp_f32 v198, v198
    v_exp_f32 v199, v199
    v_pk_add_f32 v[196:197], v[196:197], s[86:87]
    v_pk_add_f32 v[198:199], v[198:199], s[86:87]
    v_rcp_f32 v196, v196
    v_rcp_f32 v197, v197
    v_rcp_f32 v198, v198
    v_rcp_f32 v199, v199
    v_pk_mul_f32 v[196:197], v[196:197], v[164:165]
    v_pk_mul_f32 v[198:199], v[198:199], v[166:167]
    v_cvt_pk_bf16_f32 v226, v196, v197
    v_cvt_pk_bf16_f32 v227, v198, v199
    buffer_store_dwordx4 v[224:227], v0, s[24:27], s52 offen sc1
    s_waitcnt vmcnt(9)
    s_waitcnt lgkmcnt(4)
    v_mfma_f32_32x32x16_bf16 v[64:79], a[244:247], a[4:7], v[64:79]
    ds_read_b64_tr_b16 a[240:241], v33 offset:57344
    ds_read_b64_tr_b16 a[242:243], v33 offset:58368
    buffer_load_dwordx4 a[40:43], v28, s[24:27], s91 offen offset:2048 sc1
    v_pk_mul_f32 v[200:201], v[136:137], s[84:85]
    v_pk_mul_f32 v[202:203], v[138:139], s[84:85]
    v_exp_f32 v200, v200
    v_exp_f32 v201, v201
    v_exp_f32 v202, v202
    v_exp_f32 v203, v203
    v_pk_add_f32 v[200:201], v[200:201], s[86:87]
    v_pk_add_f32 v[202:203], v[202:203], s[86:87]
    v_rcp_f32 v200, v200
    v_rcp_f32 v201, v201
    v_rcp_f32 v202, v202
    v_rcp_f32 v203, v203
    v_pk_mul_f32 v[200:201], v[200:201], v[168:169]
    v_pk_mul_f32 v[202:203], v[202:203], v[170:171]
    v_cvt_pk_bf16_f32 v228, v200, v201
    v_cvt_pk_bf16_f32 v229, v202, v203
    v_pk_mul_f32 v[204:205], v[140:141], s[84:85]
    v_pk_mul_f32 v[206:207], v[142:143], s[84:85]
    v_exp_f32 v204, v204
    v_exp_f32 v205, v205
    v_exp_f32 v206, v206
    v_exp_f32 v207, v207
    v_pk_add_f32 v[204:205], v[204:205], s[86:87]
    v_pk_add_f32 v[206:207], v[206:207], s[86:87]
    v_rcp_f32 v204, v204
    v_rcp_f32 v205, v205
    v_rcp_f32 v206, v206
    v_rcp_f32 v207, v207
    v_pk_mul_f32 v[204:205], v[204:205], v[172:173]
    v_pk_mul_f32 v[206:207], v[206:207], v[174:175]
    v_cvt_pk_bf16_f32 v230, v204, v205
    v_cvt_pk_bf16_f32 v231, v206, v207
    buffer_store_dwordx4 v[228:231], v0, s[24:27], s52 offen offset:1024 sc1
    s_waitcnt vmcnt(10)
    s_waitcnt lgkmcnt(4)
    v_mfma_f32_32x32x16_bf16 v[64:79], a[248:251], a[8:11], v[64:79]
    ds_read_b64_tr_b16 a[244:245], v33 offset:59392
    ds_read_b64_tr_b16 a[246:247], v33 offset:60416
    buffer_load_dwordx4 a[44:47], v28, s[24:27], s91 offen offset:3072 sc1
    v_pk_mul_f32 v[208:209], v[144:145], s[84:85]
    v_pk_mul_f32 v[210:211], v[146:147], s[84:85]
    v_exp_f32 v208, v208
    v_exp_f32 v209, v209
    v_exp_f32 v210, v210
    v_exp_f32 v211, v211
    v_pk_add_f32 v[208:209], v[208:209], s[86:87]
    v_pk_add_f32 v[210:211], v[210:211], s[86:87]
    v_rcp_f32 v208, v208
    v_rcp_f32 v209, v209
    v_rcp_f32 v210, v210
    v_rcp_f32 v211, v211
    v_pk_mul_f32 v[208:209], v[208:209], v[176:177]
    v_pk_mul_f32 v[210:211], v[210:211], v[178:179]
    v_cvt_pk_bf16_f32 v232, v208, v209
    v_cvt_pk_bf16_f32 v233, v210, v211
    v_pk_mul_f32 v[212:213], v[148:149], s[84:85]
    v_pk_mul_f32 v[214:215], v[150:151], s[84:85]
    v_exp_f32 v212, v212
    v_exp_f32 v213, v213
    v_exp_f32 v214, v214
    v_exp_f32 v215, v215
    v_pk_add_f32 v[212:213], v[212:213], s[86:87]
    v_pk_add_f32 v[214:215], v[214:215], s[86:87]
    v_rcp_f32 v212, v212
    v_rcp_f32 v213, v213
    v_rcp_f32 v214, v214
    v_rcp_f32 v215, v215
    v_pk_mul_f32 v[212:213], v[212:213], v[180:181]
    v_pk_mul_f32 v[214:215], v[214:215], v[182:183]
    v_cvt_pk_bf16_f32 v234, v212, v213
    v_cvt_pk_bf16_f32 v235, v214, v215
    buffer_store_dwordx4 v[232:235], v0, s[24:27], s53 offen sc1
    s_waitcnt vmcnt(11)
    s_waitcnt lgkmcnt(4)
    v_mfma_f32_32x32x16_bf16 v[64:79], a[252:255], a[12:15], v[64:79]
    ds_read_b64_tr_b16 a[248:249], v33 offset:61440
    ds_read_b64_tr_b16 a[250:251], v33 offset:62464
    s_lshl_b32 s91, s67, 13
    s_add_u32 s91, s91, s71
    buffer_load_dwordx4 a[48:51], v28, s[24:27], s91 offen sc1
    v_pk_mul_f32 v[216:217], v[152:153], s[84:85]
    v_pk_mul_f32 v[218:219], v[154:155], s[84:85]
    v_exp_f32 v216, v216
    v_exp_f32 v217, v217
    v_exp_f32 v218, v218
    v_exp_f32 v219, v219
    v_pk_add_f32 v[216:217], v[216:217], s[86:87]
    v_pk_add_f32 v[218:219], v[218:219], s[86:87]
    v_rcp_f32 v216, v216
    v_rcp_f32 v217, v217
    v_rcp_f32 v218, v218
    v_rcp_f32 v219, v219
    v_pk_mul_f32 v[216:217], v[216:217], v[184:185]
    v_pk_mul_f32 v[218:219], v[218:219], v[186:187]
    v_cvt_pk_bf16_f32 v236, v216, v217
    v_cvt_pk_bf16_f32 v237, v218, v219
    v_pk_mul_f32 v[220:221], v[156:157], s[84:85]
    v_pk_mul_f32 v[222:223], v[158:159], s[84:85]
    v_exp_f32 v220, v220
    v_exp_f32 v221, v221
    v_exp_f32 v222, v222
    v_exp_f32 v223, v223
    v_pk_add_f32 v[220:221], v[220:221], s[86:87]
    v_pk_add_f32 v[222:223], v[222:223], s[86:87]
    v_rcp_f32 v220, v220
    v_rcp_f32 v221, v221
    v_rcp_f32 v222, v222
    v_rcp_f32 v223, v223
    v_pk_mul_f32 v[220:221], v[220:221], v[188:189]
    v_pk_mul_f32 v[222:223], v[222:223], v[190:191]
    v_cvt_pk_bf16_f32 v238, v220, v221
    v_cvt_pk_bf16_f32 v239, v222, v223
    buffer_store_dwordx4 v[236:239], v0, s[24:27], s53 offen offset:1024 sc1
    s_waitcnt vmcnt(12)
    s_waitcnt lgkmcnt(4)
    v_mfma_f32_32x32x16_bf16 v[64:79], a[240:243], a[16:19], v[64:79]
    ds_read_b64_tr_b16 a[252:253], v33 offset:63488
    ds_read_b64_tr_b16 a[254:255], v33 offset:64512
    buffer_load_dwordx4 a[52:55], v28, s[24:27], s91 offen offset:1024 sc1
    buffer_load_dwordx4 a[56:59], v28, s[24:27], s91 offen offset:2048 sc1
    s_waitcnt vmcnt(13)
    s_waitcnt lgkmcnt(4)
    v_mfma_f32_32x32x16_bf16 v[64:79], a[244:247], a[20:23], v[64:79]
    ds_read_b64_tr_b16 a[240:241], v34 offset:0
    ds_read_b64_tr_b16 a[242:243], v34 offset:1024
    buffer_load_dwordx4 a[60:63], v28, s[24:27], s91 offen offset:3072 sc1
    s_waitcnt vmcnt(13)
    s_waitcnt lgkmcnt(4)
    v_mfma_f32_32x32x16_bf16 v[64:79], a[248:251], a[24:27], v[64:79]
    ds_read_b64_tr_b16 a[244:245], v34 offset:2048
    ds_read_b64_tr_b16 a[246:247], v34 offset:3072
    s_lshl_b32 s91, s68, 13
    s_add_u32 s91, s91, s71
    buffer_load_dwordx4 a[64:67], v28, s[24:27], s91 offen sc1
    s_waitcnt vmcnt(13)
    s_waitcnt lgkmcnt(4)
    v_mfma_f32_32x32x16_bf16 v[64:79], a[252:255], a[28:31], v[64:79]
    ds_read_b64_tr_b16 a[248:249], v34 offset:4096
    ds_read_b64_tr_b16 a[250:251], v34 offset:5120
    buffer_load_dwordx4 a[68:71], v28, s[24:27], s91 offen offset:1024 sc1
    s_waitcnt vmcnt(13)
    s_waitcnt lgkmcnt(4)
    v_mfma_f32_32x32x16_bf16 v[64:79], a[240:243], a[32:35], v[64:79]
    ds_read_b64_tr_b16 a[252:253], v34 offset:6144
    ds_read_b64_tr_b16 a[254:255], v34 offset:7168
    buffer_load_dwordx4 a[72:75], v28, s[24:27], s91 offen offset:2048 sc1
    buffer_load_dwordx4 a[76:79], v28, s[24:27], s91 offen offset:3072 sc1
    s_waitcnt vmcnt(14)
    s_waitcnt lgkmcnt(4)
    v_mfma_f32_32x32x16_bf16 v[64:79], a[244:247], a[36:39], v[64:79]
    ds_read_b64_tr_b16 a[240:241], v34 offset:8192
    ds_read_b64_tr_b16 a[242:243], v34 offset:9216
    s_lshl_b32 s91, s69, 13
    s_add_u32 s91, s91, s71
    buffer_load_dwordx4 a[80:83], v28, s[24:27], s91 offen sc1
    s_waitcnt vmcnt(13)
    s_waitcnt lgkmcnt(4)
    v_mfma_f32_32x32x16_bf16 v[64:79], a[248:251], a[40:43], v[64:79]
    ds_read_b64_tr_b16 a[244:245], v34 offset:10240
    ds_read_b64_tr_b16 a[246:247], v34 offset:11264
    buffer_load_dwordx4 a[84:87], v28, s[24:27], s91 offen offset:1024 sc1
    v_mul_f32 v196, 4.0, v40
    v_mov_b32 v192, v45
    v_add_f32 v193, v192, v40
    s_waitcnt vmcnt(12)
    s_waitcnt lgkmcnt(4)
    v_mfma_f32_32x32x16_bf16 v[64:79], a[252:255], a[44:47], v[64:79]
    ds_read_b64_tr_b16 a[248:249], v34 offset:12288
    ds_read_b64_tr_b16 a[250:251], v34 offset:13312
    buffer_load_dwordx4 a[88:91], v28, s[24:27], s91 offen offset:2048 sc1
    v_add_f32 v194, v193, v40
    v_add_f32 v195, v194, v40
    v_cos_f32 v200, v192
    s_waitcnt vmcnt(11)
    s_waitcnt lgkmcnt(4)
    v_mfma_f32_32x32x16_bf16 v[64:79], a[240:243], a[48:51], v[64:79]
    ds_read_b64_tr_b16 a[252:253], v34 offset:14336
    ds_read_b64_tr_b16 a[254:255], v34 offset:15360
    buffer_load_dwordx4 a[92:95], v28, s[24:27], s91 offen offset:3072 sc1
    s_lshl_b32 s91, s70, 13
    s_add_u32 s91, s91, s71
    buffer_load_dwordx4 a[96:99], v28, s[24:27], s91 offen sc1
    v_cos_f32 v201, v193
    v_cos_f32 v202, v194
    v_cos_f32 v203, v195
    s_waitcnt vmcnt(11)
    s_waitcnt lgkmcnt(4)
    v_mfma_f32_32x32x16_bf16 v[64:79], a[244:247], a[52:55], v[64:79]
    ds_read_b64_tr_b16 a[240:241], v34 offset:16384
    ds_read_b64_tr_b16 a[242:243], v34 offset:17408
    buffer_load_dwordx4 a[100:103], v28, s[24:27], s91 offen offset:1024 sc1
    v_add_f32 v192, v192, v196
    v_add_f32 v193, v193, v196
    v_add_f32 v194, v194, v196
    s_waitcnt vmcnt(11)
    s_waitcnt lgkmcnt(4)
    v_mfma_f32_32x32x16_bf16 v[64:79], a[248:251], a[56:59], v[64:79]
    ds_read_b64_tr_b16 a[244:245], v34 offset:18432
    ds_read_b64_tr_b16 a[246:247], v34 offset:19456
    buffer_load_dwordx4 a[104:107], v28, s[24:27], s91 offen offset:2048 sc1
    v_add_f32 v195, v195, v196
    v_cvt_pk_bf16_f32 v128, v200, v201
    v_cvt_pk_bf16_f32 v129, v202, v203
    s_waitcnt vmcnt(11)
    s_waitcnt lgkmcnt(4)
    v_mfma_f32_32x32x16_bf16 v[64:79], a[252:255], a[60:63], v[64:79]
    ds_read_b64_tr_b16 a[248:249], v34 offset:20480
    ds_read_b64_tr_b16 a[250:251], v34 offset:21504
    buffer_load_dwordx4 a[108:111], v28, s[24:27], s91 offen offset:3072 sc1
    v_cos_f32 v204, v192
    v_cos_f32 v205, v193
    v_cos_f32 v206, v194
    s_waitcnt vmcnt(11)
    s_waitcnt lgkmcnt(4)
    v_mfma_f32_32x32x16_bf16 v[64:79], a[240:243], a[64:67], v[64:79]
    ds_read_b64_tr_b16 a[252:253], v34 offset:22528
    ds_read_b64_tr_b16 a[254:255], v34 offset:23552
    buffer_store_dword v61, off, s[44:47], s56 offset:4 sc1
    v_cos_f32 v207, v195
    v_add_f32 v192, v192, v196
    v_add_f32 v193, v193, v196
    s_waitcnt vmcnt(11)
    s_waitcnt lgkmcnt(4)
    v_mfma_f32_32x32x16_bf16 v[64:79], a[244:247], a[68:71], v[64:79]
    ds_read_b64_tr_b16 a[240:241], v34 offset:24576
    ds_read_b64_tr_b16 a[242:243], v34 offset:25600
    v_add_f32 v194, v194, v196
    v_add_f32 v195, v195, v196
    v_cvt_pk_bf16_f32 v130, v204, v205
    s_waitcnt vmcnt(10)
    s_waitcnt lgkmcnt(4)
    v_mfma_f32_32x32x16_bf16 v[64:79], a[248:251], a[72:75], v[64:79]
    ds_read_b64_tr_b16 a[244:245], v34 offset:26624
    ds_read_b64_tr_b16 a[246:247], v34 offset:27648
    v_cvt_pk_bf16_f32 v131, v206, v207
    v_cos_f32 v200, v192
    v_cos_f32 v201, v193
    s_waitcnt vmcnt(9)
    s_waitcnt lgkmcnt(4)
    v_mfma_f32_32x32x16_bf16 v[64:79], a[252:255], a[76:79], v[64:79]
    ds_read_b64_tr_b16 a[248:249], v34 offset:28672
    ds_read_b64_tr_b16 a[250:251], v34 offset:29696
    v_cos_f32 v202, v194
    v_cos_f32 v203, v195
    v_add_f32 v192, v192, v196
    s_waitcnt vmcnt(8)
    s_waitcnt lgkmcnt(4)
    v_mfma_f32_32x32x16_bf16 v[64:79], a[240:243], a[80:83], v[64:79]
    ds_read_b64_tr_b16 a[252:253], v34 offset:30720
    ds_read_b64_tr_b16 a[254:255], v34 offset:31744
    v_add_f32 v193, v193, v196
    v_add_f32 v194, v194, v196
    v_add_f32 v195, v195, v196
    s_waitcnt vmcnt(7)
    s_waitcnt lgkmcnt(4)
    v_mfma_f32_32x32x16_bf16 v[64:79], a[244:247], a[84:87], v[64:79]
    ds_read_b64_tr_b16 a[240:241], v33 offset:16384
    ds_read_b64_tr_b16 a[242:243], v33 offset:17408
    v_cvt_pk_bf16_f32 v132, v200, v201
    v_cvt_pk_bf16_f32 v133, v202, v203
    v_cos_f32 v204, v192
    s_waitcnt vmcnt(6)
    s_waitcnt lgkmcnt(4)
    v_mfma_f32_32x32x16_bf16 v[64:79], a[248:251], a[88:91], v[64:79]
    ds_read_b64_tr_b16 a[244:245], v33 offset:18432
    ds_read_b64_tr_b16 a[246:247], v33 offset:19456
    v_cos_f32 v205, v193
    v_cos_f32 v206, v194
    v_cos_f32 v207, v195
    s_waitcnt vmcnt(5)
    s_waitcnt lgkmcnt(4)
    v_mfma_f32_32x32x16_bf16 v[64:79], a[252:255], a[92:95], v[64:79]
    ds_read_b64_tr_b16 a[248:249], v33 offset:20480
    ds_read_b64_tr_b16 a[250:251], v33 offset:21504
    v_add_f32 v192, v192, v196
    v_add_f32 v193, v193, v196
    v_add_f32 v194, v194, v196
    s_waitcnt vmcnt(4)
    s_waitcnt lgkmcnt(4)
    v_mfma_f32_32x32x16_bf16 v[64:79], a[240:243], a[96:99], v[64:79]
    ds_read_b64_tr_b16 a[252:253], v33 offset:22528
    ds_read_b64_tr_b16 a[254:255], v33 offset:23552
    v_add_f32 v195, v195, v196
    v_cvt_pk_bf16_f32 v134, v204, v205
    v_cvt_pk_bf16_f32 v135, v206, v207
    s_waitcnt vmcnt(3)
    s_waitcnt lgkmcnt(4)
    v_mfma_f32_32x32x16_bf16 v[64:79], a[244:247], a[100:103], v[64:79]
    ds_read_b64_tr_b16 a[240:241], v36 offset:49152
    ds_read_b64_tr_b16 a[242:243], v36 offset:50176
    v_cos_f32 v200, v192
    v_cos_f32 v201, v193
    v_cos_f32 v202, v194
    s_waitcnt vmcnt(2)
    s_waitcnt lgkmcnt(4)
    v_mfma_f32_32x32x16_bf16 v[64:79], a[248:251], a[104:107], v[64:79]
    ds_read_b64_tr_b16 a[244:245], v36 offset:51200
    ds_read_b64_tr_b16 a[246:247], v36 offset:52224
    v_cos_f32 v203, v195
    v_add_f32 v192, v192, v196
    v_add_f32 v193, v193, v196
    s_waitcnt vmcnt(1)
    s_waitcnt lgkmcnt(4)
    v_mfma_f32_32x32x16_bf16 v[64:79], a[252:255], a[108:111], v[64:79]
    ds_read_b64_tr_b16 a[248:249], v36 offset:53248
    ds_read_b64_tr_b16 a[250:251], v36 offset:54272
    v_add_f32 v194, v194, v196
    v_add_f32 v195, v195, v196
    v_cvt_pk_bf16_f32 v136, v200, v201
    s_waitcnt lgkmcnt(4)
    v_mfma_f32_32x32x16_bf16 v[80:95], a[240:243], a[0:3], 0
    ds_read_b64_tr_b16 a[252:253], v36 offset:55296
    ds_read_b64_tr_b16 a[254:255], v36 offset:56320
    v_cvt_pk_bf16_f32 v137, v202, v203
    v_cos_f32 v204, v192
    v_cos_f32 v205, v193
    s_waitcnt lgkmcnt(4)
    v_mfma_f32_32x32x16_bf16 v[80:95], a[244:247], a[4:7], v[80:95]
    ds_read_b64_tr_b16 a[240:241], v36 offset:57344
    ds_read_b64_tr_b16 a[242:243], v36 offset:58368
    v_cos_f32 v206, v194
    v_cos_f32 v207, v195
    v_add_f32 v192, v192, v196
    s_waitcnt lgkmcnt(4)
    v_mfma_f32_32x32x16_bf16 v[80:95], a[248:251], a[8:11], v[80:95]
    ds_read_b64_tr_b16 a[244:245], v36 offset:59392
    ds_read_b64_tr_b16 a[246:247], v36 offset:60416
    v_add_f32 v193, v193, v196
    v_add_f32 v194, v194, v196
    v_add_f32 v195, v195, v196
    s_waitcnt lgkmcnt(4)
    v_mfma_f32_32x32x16_bf16 v[80:95], a[252:255], a[12:15], v[80:95]
    ds_read_b64_tr_b16 a[248:249], v36 offset:61440
    ds_read_b64_tr_b16 a[250:251], v36 offset:62464
    v_cvt_pk_bf16_f32 v138, v204, v205
    v_cvt_pk_bf16_f32 v139, v206, v207
    v_cos_f32 v200, v192
    s_waitcnt lgkmcnt(4)
    v_mfma_f32_32x32x16_bf16 v[80:95], a[240:243], a[16:19], v[80:95]
    ds_read_b64_tr_b16 a[252:253], v36 offset:63488
    ds_read_b64_tr_b16 a[254:255], v36 offset:64512
    v_cos_f32 v201, v193
    v_cos_f32 v202, v194
    v_cos_f32 v203, v195
    s_waitcnt lgkmcnt(4)
    v_mfma_f32_32x32x16_bf16 v[80:95], a[244:247], a[20:23], v[80:95]
    ds_read_b64_tr_b16 a[240:241], v37 offset:0
    ds_read_b64_tr_b16 a[242:243], v37 offset:1024
    v_add_f32 v192, v192, v196
    v_add_f32 v193, v193, v196
    v_add_f32 v194, v194, v196
    s_waitcnt lgkmcnt(4)
    v_mfma_f32_32x32x16_bf16 v[80:95], a[248:251], a[24:27], v[80:95]
    ds_read_b64_tr_b16 a[244:245], v37 offset:2048
    ds_read_b64_tr_b16 a[246:247], v37 offset:3072
    v_add_f32 v195, v195, v196
    v_cvt_pk_bf16_f32 v140, v200, v201
    v_cvt_pk_bf16_f32 v141, v202, v203
    s_waitcnt lgkmcnt(4)
    v_mfma_f32_32x32x16_bf16 v[80:95], a[252:255], a[28:31], v[80:95]
    ds_read_b64_tr_b16 a[248:249], v37 offset:4096
    ds_read_b64_tr_b16 a[250:251], v37 offset:5120
    v_cos_f32 v204, v192
    v_cos_f32 v205, v193
    v_cos_f32 v206, v194
    s_waitcnt lgkmcnt(4)
    v_mfma_f32_32x32x16_bf16 v[80:95], a[240:243], a[32:35], v[80:95]
    ds_read_b64_tr_b16 a[252:253], v37 offset:6144
    ds_read_b64_tr_b16 a[254:255], v37 offset:7168
    v_cos_f32 v207, v195
    v_add_f32 v192, v192, v196
    v_add_f32 v193, v193, v196
    s_waitcnt lgkmcnt(4)
    v_mfma_f32_32x32x16_bf16 v[80:95], a[244:247], a[36:39], v[80:95]
    ds_read_b64_tr_b16 a[240:241], v37 offset:8192
    ds_read_b64_tr_b16 a[242:243], v37 offset:9216
    v_add_f32 v194, v194, v196
    v_add_f32 v195, v195, v196
    v_cvt_pk_bf16_f32 v142, v204, v205
    s_waitcnt lgkmcnt(4)
    v_mfma_f32_32x32x16_bf16 v[80:95], a[248:251], a[40:43], v[80:95]
    ds_read_b64_tr_b16 a[244:245], v37 offset:10240
    ds_read_b64_tr_b16 a[246:247], v37 offset:11264
    v_cvt_pk_bf16_f32 v143, v206, v207
    v_cos_f32 v200, v192
    v_cos_f32 v201, v193
    s_waitcnt lgkmcnt(4)
    v_mfma_f32_32x32x16_bf16 v[80:95], a[252:255], a[44:47], v[80:95]
    ds_read_b64_tr_b16 a[248:249], v37 offset:12288
    ds_read_b64_tr_b16 a[250:251], v37 offset:13312
    v_cos_f32 v202, v194
    v_cos_f32 v203, v195
    v_add_f32 v192, v192, v196
    s_waitcnt lgkmcnt(4)
    v_mfma_f32_32x32x16_bf16 v[80:95], a[240:243], a[48:51], v[80:95]
    ds_read_b64_tr_b16 a[252:253], v37 offset:14336
    ds_read_b64_tr_b16 a[254:255], v37 offset:15360
    v_add_f32 v193, v193, v196
    v_add_f32 v194, v194, v196
    v_add_f32 v195, v195, v196
    s_waitcnt lgkmcnt(4)
    v_mfma_f32_32x32x16_bf16 v[80:95], a[244:247], a[52:55], v[80:95]
    ds_read_b64_tr_b16 a[240:241], v37 offset:16384
    ds_read_b64_tr_b16 a[242:243], v37 offset:17408
    v_cvt_pk_bf16_f32 v144, v200, v201
    v_cvt_pk_bf16_f32 v145, v202, v203
    v_cos_f32 v204, v192
    s_waitcnt lgkmcnt(4)
    v_mfma_f32_32x32x16_bf16 v[80:95], a[248:251], a[56:59], v[80:95]
    ds_read_b64_tr_b16 a[244:245], v37 offset:18432
    ds_read_b64_tr_b16 a[246:247], v37 offset:19456
    v_cos_f32 v205, v193
    v_cos_f32 v206, v194
    v_cos_f32 v207, v195
    s_waitcnt lgkmcnt(4)
    v_mfma_f32_32x32x16_bf16 v[80:95], a[252:255], a[60:63], v[80:95]
    ds_read_b64_tr_b16 a[248:249], v37 offset:20480
    ds_read_b64_tr_b16 a[250:251], v37 offset:21504
    v_add_f32 v192, v192, v196
    v_add_f32 v193, v193, v196
    v_add_f32 v194, v194, v196
    s_waitcnt lgkmcnt(4)
    v_mfma_f32_32x32x16_bf16 v[80:95], a[240:243], a[64:67], v[80:95]
    ds_read_b64_tr_b16 a[252:253], v37 offset:22528
    ds_read_b64_tr_b16 a[254:255], v37 offset:23552
    v_add_f32 v195, v195, v196
    v_cvt_pk_bf16_f32 v146, v204, v205
    v_cvt_pk_bf16_f32 v147, v206, v207
    buffer_load_dword v18, v43, s[44:47], s57 offen offset:4 sc1
    s_waitcnt lgkmcnt(4)
    v_mfma_f32_32x32x16_bf16 v[80:95], a[244:247], a[68:71], v[80:95]
    ds_read_b64_tr_b16 a[240:241], v37 offset:24576
    ds_read_b64_tr_b16 a[242:243], v37 offset:25600
    v_cos_f32 v200, v192
    v_cos_f32 v201, v193
    v_cos_f32 v202, v194
    s_waitcnt lgkmcnt(4)
    v_mfma_f32_32x32x16_bf16 v[80:95], a[248:251], a[72:75], v[80:95]
    ds_read_b64_tr_b16 a[244:245], v37 offset:26624
    ds_read_b64_tr_b16 a[246:247], v37 offset:27648
    v_cos_f32 v203, v195
    v_add_f32 v192, v192, v196
    v_add_f32 v193, v193, v196
    s_waitcnt lgkmcnt(4)
    v_mfma_f32_32x32x16_bf16 v[80:95], a[252:255], a[76:79], v[80:95]
    ds_read_b64_tr_b16 a[248:249], v37 offset:28672
    ds_read_b64_tr_b16 a[250:251], v37 offset:29696
    v_add_f32 v194, v194, v196
    v_add_f32 v195, v195, v196
    v_cvt_pk_bf16_f32 v148, v200, v201
    s_waitcnt lgkmcnt(4)
    v_mfma_f32_32x32x16_bf16 v[80:95], a[240:243], a[80:83], v[80:95]
    ds_read_b64_tr_b16 a[252:253], v37 offset:30720
    ds_read_b64_tr_b16 a[254:255], v37 offset:31744
    v_cvt_pk_bf16_f32 v149, v202, v203
    v_cos_f32 v204, v192
    v_cos_f32 v205, v193
    s_waitcnt lgkmcnt(4)
    v_mfma_f32_32x32x16_bf16 v[80:95], a[244:247], a[84:87], v[80:95]
    ds_read_b64_tr_b16 a[240:241], v36 offset:16384
    ds_read_b64_tr_b16 a[242:243], v36 offset:17408
    v_cos_f32 v206, v194
    v_cos_f32 v207, v195
    v_add_f32 v192, v192, v196
    s_waitcnt lgkmcnt(4)
    v_mfma_f32_32x32x16_bf16 v[80:95], a[248:251], a[88:91], v[80:95]
    ds_read_b64_tr_b16 a[244:245], v36 offset:18432
    ds_read_b64_tr_b16 a[246:247], v36 offset:19456
    v_add_f32 v193, v193, v196
    v_add_f32 v194, v194, v196
    v_add_f32 v195, v195, v196
    s_waitcnt lgkmcnt(4)
    v_mfma_f32_32x32x16_bf16 v[80:95], a[252:255], a[92:95], v[80:95]
    ds_read_b64_tr_b16 a[248:249], v36 offset:20480
    ds_read_b64_tr_b16 a[250:251], v36 offset:21504
    v_cvt_pk_bf16_f32 v150, v204, v205
    v_cvt_pk_bf16_f32 v151, v206, v207
    v_cos_f32 v200, v192
    s_waitcnt vmcnt(0)
    v_cmp_eq_u32 vcc, s55, v18
    s_nop 3
    s_and_b32 s5, vcc_lo, 0x3fff
    s_cmp_eq_u32 s5, 0x3fff
    s_cbranch_scc1 L_poll_ok_5
    s_mov_b32 s62, 0x40000
L_poll_lp_6:
    s_sleep 1
    buffer_load_dword v18, v43, s[44:47], s57 offen offset:4 sc1
    s_waitcnt vmcnt(0)
    s_sub_u32 s62, s62, 1
    s_cmp_eq_u32 s62, 0
    s_cbranch_scc1 L_poll_ok_5
    v_cmp_eq_u32 vcc, s55, v18
    s_nop 3
    s_and_b32 s5, vcc_lo, 0x3fff
    s_cmp_eq_u32 s5, 0x3fff
    s_cbranch_scc0 L_poll_lp_6
L_poll_ok_5:
    s_lshl_b32 s91, s64, 13
    s_add_u32 s91, s91, s71
    buffer_load_dwordx4 a[112:115], v0, s[24:27], s91 offen sc1
    buffer_load_dwordx4 a[116:119], v0, s[24:27], s91 offen offset:1024 sc1
    buffer_load_dwordx4 a[120:123], v0, s[24:27], s91 offen offset:2048 sc1
    buffer_load_dwordx4 a[124:127], v0, s[24:27], s91 offen offset:3072 sc1
    s_waitcnt lgkmcnt(4)
    v_mfma_f32_32x32x16_bf16 v[80:95], a[240:243], a[96:99], v[80:95]
    ds_read_b64_tr_b16 a[252:253], v36 offset:22528
    ds_read_b64_tr_b16 a[254:255], v36 offset:23552
    v_cos_f32 v201, v193
    v_cos_f32 v202, v194
    v_cos_f32 v203, v195
    s_lshl_b32 s91, s65, 13
    s_add_u32 s91, s91, s71
    buffer_load_dwordx4 a[128:131], v0, s[24:27], s91 offen sc1
    buffer_load_dwordx4 a[132:135], v0, s[24:27], s91 offen offset:1024 sc1
    s_waitcnt lgkmcnt(4)
    v_mfma_f32_32x32x16_bf16 v[80:95], a[244:247], a[100:103], v[80:95]
    ds_read_b64_tr_b16 a[240:241], v33 offset:24576
    ds_read_b64_tr_b16 a[242:243], v33 offset:25600
    v_add_f32 v192, v192, v196
    v_add_f32 v193, v193, v196
    v_add_f32 v194, v194, v196
    buffer_load_dwordx4 a[136:139], v0, s[24:27], s91 offen offset:2048 sc1
    s_waitcnt lgkmcnt(4)
    v_mfma_f32_32x32x16_bf16 v[80:95], a[248:251], a[104:107], v[80:95]
    ds_read_b64_tr_b16 a[244:245], v33 offset:26624
    ds_read_b64_tr_b16 a[246:247], v33 offset:27648
    v_add_f32 v195, v195, v196
    v_cvt_pk_bf16_f32 v152, v200, v201
    v_cvt_pk_bf16_f32 v153, v202, v203
    buffer_load_dwordx4 a[140:143], v0, s[24:27], s91 offen offset:3072 sc1
    s_waitcnt lgkmcnt(4)
    v_mfma_f32_32x32x16_bf16 v[80:95], a[252:255], a[108:111], v[80:95]
    ds_read_b64_tr_b16 a[248:249], v33 offset:28672
    ds_read_b64_tr_b16 a[250:251], v33 offset:29696
    v_cos_f32 v204, v192
    v_cos_f32 v205, v193
    v_cos_f32 v206, v194
    s_lshl_b32 s91, s66, 13
    s_add_u32 s91, s91, s71
    buffer_load_dwordx4 a[144:147], v0, s[24:27], s91 offen sc1
    s_waitcnt vmcnt(8)
    s_waitcnt lgkmcnt(4)
    v_mfma_f32_32x32x16_bf16 v[64:79], a[240:243], a[112:115], v[64:79]
    ds_read_b64_tr_b16 a[252:253], v33 offset:30720
    ds_read_b64_tr_b16 a[254:255], v33 offset:31744
    v_cos_f32 v207, v195
    v_add_f32 v192, v192, v196
    v_add_f32 v193, v193, v196
    buffer_load_dwordx4 a[148:151], v0, s[24:27], s91 offen offset:1024 sc1
    s_waitcnt vmcnt(8)
    s_waitcnt lgkmcnt(4)
    v_mfma_f32_32x32x16_bf16 v[64:79], a[244:247], a[116:119], v[64:79]
    ds_read_b64_tr_b16 a[240:241], v33 offset:32768
    ds_read_b64_tr_b16 a[242:243], v33 offset:33792
    v_add_f32 v194, v194, v196
    v_add_f32 v195, v195, v196
    v_cvt_pk_bf16_f32 v154, v204, v205
    buffer_load_dwordx4 a[152:155], v0, s[24:27], s91 offen offset:2048 sc1
    buffer_load_dwordx4 a[156:159], v0, s[24:27], s91 offen offset:3072 sc1
    s_waitcnt vmcnt(9)
    s_waitcnt lgkmcnt(4)
    v_mfma_f32_32x32x16_bf16 v[64:79], a[248:251], a[120:123], v[64:79]
    ds_read_b64_tr_b16 a[244:245], v33 offset:34816
    ds_read_b64_tr_b16 a[246:247], v33 offset:35840
    v_cvt_pk_bf16_f32 v155, v206, v207
    v_cos_f32 v200, v192
    v_cos_f32 v201, v193
    s_lshl_b32 s91, s67, 13
    s_add_u32 s91, s91, s71
    buffer_load_dwordx4 a[160:163], v0, s[24:27], s91 offen sc1
    s_waitcnt vmcnt(9)
    s_waitcnt lgkmcnt(4)
    v_mfma_f32_32x32x16_bf16 v[64:79], a[252:255], a[124:127], v[64:79]
    ds_read_b64_tr_b16 a[248:249], v33 offset:36864
    ds_read_b64_tr_b16 a[250:251], v33 offset:37888
    v_cos_f32 v202, v194
    v_cos_f32 v203, v195
    v_add_f32 v192, v192, v196
    buffer_load_dwordx4 a[164:167], v0, s[24:27], s91 offen offset:1024 sc1
    s_waitcnt vmcnt(9)
    s_waitcnt lgkmcnt(4)
    v_mfma_f32_32x32x16_bf16 v[64:79], a[240:243], a[128:131], v[64:79]
    ds_read_b64_tr_b16 a[252:253], v33 offset:38912
    ds_read_b64_tr_b16 a[254:255], v33 offset:39936
    v_add_f32 v193, v193, v196
    v_add_f32 v194, v194, v196
    v_add_f32 v195, v195, v196
    buffer_load_dwordx4 a[168:171], v0, s[24:27], s91 offen offset:2048 sc1
    s_waitcnt vmcnt(9)
    s_waitcnt lgkmcnt(4)
    v_mfma_f32_32x32x16_bf16 v[64:79], a[244:247], a[132:135], v[64:79]
    ds_read_b64_tr_b16 a[240:241], v33 offset:40960
    ds_read_b64_tr_b16 a[242:243], v33 offset:41984
    v_cvt_pk_bf16_f32 v156, v200, v201
    v_cvt_pk_bf16_f32 v157, v202, v203
    v_cos_f32 v204, v192
    buffer_load_dwordx4 a[172:175], v0, s[24:27], s91 offen offset:3072 sc1
    s_waitcnt vmcnt(9)
    s_waitcnt lgkmcnt(4)
    v_mfma_f32_32x32x16_bf16 v[64:79], a[248:251], a[136:139], v[64:79]
    ds_read_b64_tr_b16 a[244:245], v33 offset:43008
    ds_read_b64_tr_b16 a[246:247], v33 offset:44032
    v_cos_f32 v205, v193
    v_cos_f32 v206, v194
    v_cos_f32 v207, v195
    s_lshl_b32 s91, s68, 13
    s_add_u32 s91, s91, s71
    buffer_load_dwordx4 a[176:179], v0, s[24:27], s91 offen sc1
    buffer_load_dwordx4 a[180:183], v0, s[24:27], s91 offen offset:1024 sc1
    s_waitcnt vmcnt(10)
    s_waitcnt lgkmcnt(4)
    v_mfma_f32_32x32x16_bf16 v[64:79], a[252:255], a[140:143], v[64:79]
    ds_read_b64_tr_b16 a[248:249], v33 offset:45056
    ds_read_b64_tr_b16 a[250:251], v33 offset:46080
    s_nop 0
    v_cvt_pk_bf16_f32 v158, v204, v205
    v_cvt_pk_bf16_f32 v159, v206, v207
    buffer_load_dwordx4 a[184:187], v0, s[24:27], s91 offen offset:2048 sc1
    s_waitcnt vmcnt(10)
    s_waitcnt lgkmcnt(4)
    v_mfma_f32_32x32x16_bf16 v[64:79], a[240:243], a[144:147], v[64:79]
    ds_read_b64_tr_b16 a[252:253], v33 offset:47104
    ds_read_b64_tr_b16 a[254:255], v33 offset:48128
    buffer_load_dwordx4 a[188:191], v0, s[24:27], s91 offen offset:3072 sc1
    s_waitcnt vmcnt(10)
    s_waitcnt lgkmcnt(4)
    v_mfma_f32_32x32x16_bf16 v[64:79], a[244:247], a[148:151], v[64:79]
    ds_read_b64_tr_b16 a[240:241], v32 offset:0
    ds_read_b64_tr_b16 a[242:243], v32 offset:1024
    s_lshl_b32 s91, s69, 13
    s_add_u32 s91, s91, s71
    buffer_load_dwordx4 a[192:195], v0, s[24:27], s91 offen sc1
    s_waitcnt vmcnt(10)
    s_waitcnt lgkmcnt(4)
    v_mfma_f32_32x32x16_bf16 v[64:79], a[248:251], a[152:155], v[64:79]
    ds_read_b64_tr_b16 a[244:245], v32 offset:2048
    ds_read_b64_tr_b16 a[246:247], v32 offset:3072
    buffer_load_dwordx4 a[196:199], v0, s[24:27], s91 offen offset:1024 sc1
    s_waitcnt vmcnt(10)
    s_waitcnt lgkmcnt(4)
    v_mfma_f32_32x32x16_bf16 v[64:79], a[252:255], a[156:159], v[64:79]
    ds_read_b64_tr_b16 a[248:249], v32 offset:4096
    ds_read_b64_tr_b16 a[250:251], v32 offset:5120
    buffer_load_dwordx4 a[200:203], v0, s[24:27], s91 offen offset:2048 sc1
    buffer_load_dwordx4 a[204:207], v0, s[24:27], s91 offen offset:3072 sc1
    s_waitcnt vmcnt(11)
    s_waitcnt lgkmcnt(4)
    v_mfma_f32_32x32x16_bf16 v[64:79], a[240:243], a[160:163], v[64:79]
    ds_read_b64_tr_b16 a[252:253], v32 offset:6144
    ds_read_b64_tr_b16 a[254:255], v32 offset:7168
    s_lshl_b32 s91, s70, 13
    s_add_u32 s91, s91, s71
    buffer_load_dwordx4 a[208:211], v0, s[24:27], s91 offen sc1
    s_waitcnt vmcnt(11)
    s_waitcnt lgkmcnt(4)
    v_mfma_f32_32x32x16_bf16 v[64:79], a[244:247], a[164:167], v[64:79]
    ds_read_b64_tr_b16 a[240:241], v32 offset:8192
    ds_read_b64_tr_b16 a[242:243], v32 offset:9216
    buffer_load_dwordx4 a[212:215], v0, s[24:27], s91 offen offset:1024 sc1
    s_waitcnt vmcnt(11)
    s_waitcnt lgkmcnt(4)
    v_mfma_f32_32x32x16_bf16 v[64:79], a[248:251], a[168:171], v[64:79]
    ds_read_b64_tr_b16 a[244:245], v32 offset:10240
    ds_read_b64_tr_b16 a[246:247], v32 offset:11264
    buffer_load_dwordx4 a[216:219], v0, s[24:27], s91 offen offset:2048 sc1
    s_mov_b32 s6, 114688
    v_lshlrev_b32 v43, 7, v1
    buffer_load_dword v18, v43, s[44:47], s6 offen offset:0 sc1
    s_waitcnt vmcnt(12)
    s_waitcnt lgkmcnt(4)
    v_mfma_f32_32x32x16_bf16 v[64:79], a[252:255], a[172:175], v[64:79]
    ds_read_b64_tr_b16 a[248:249], v32 offset:12288
    ds_read_b64_tr_b16 a[250:251], v32 offset:13312
    buffer_load_dwordx4 a[220:223], v0, s[24:27], s91 offen offset:3072 sc1
    s_waitcnt vmcnt(12)
    s_waitcnt lgkmcnt(4)
    v_mfma_f32_32x32x16_bf16 v[64:79], a[240:243], a[176:179], v[64:79]
    ds_read_b64_tr_b16 a[252:253], v32 offset:14336
    ds_read_b64_tr_b16 a[254:255], v32 offset:15360
    s_waitcnt vmcnt(11)
    s_waitcnt lgkmcnt(4)
    v_mfma_f32_32x32x16_bf16 v[64:79], a[244:247], a[180:183], v[64:79]
    ds_read_b64_tr_b16 a[240:241], v33 offset:0
    ds_read_b64_tr_b16 a[242:243], v33 offset:1024
    s_waitcnt vmcnt(10)
    s_waitcnt lgkmcnt(4)
    v_mfma_f32_32x32x16_bf16 v[64:79], a[248:251], a[184:187], v[64:79]
    ds_read_b64_tr_b16 a[244:245], v33 offset:2048
    ds_read_b64_tr_b16 a[246:247], v33 offset:3072
    s_waitcnt vmcnt(9)
    s_waitcnt lgkmcnt(4)
    v_mfma_f32_32x32x16_bf16 v[64:79], a[252:255], a[188:191], v[64:79]
    ds_read_b64_tr_b16 a[248:249], v33 offset:4096
    ds_read_b64_tr_b16 a[250:251], v33 offset:5120
    s_waitcnt vmcnt(8)
    s_waitcnt lgkmcnt(4)
    v_mfma_f32_32x32x16_bf16 v[64:79], a[240:243], a[192:195], v[64:79]
    ds_read_b64_tr_b16 a[252:253], v33 offset:6144
    ds_read_b64_tr_b16 a[254:255], v33 offset:7168
    s_waitcnt vmcnt(7)
    s_waitcnt lgkmcnt(4)
    v_mfma_f32_32x32x16_bf16 v[64:79], a[244:247], a[196:199], v[64:79]
    ds_read_b64_tr_b16 a[240:241], v33 offset:8192
    ds_read_b64_tr_b16 a[242:243], v33 offset:9216
    s_waitcnt vmcnt(6)
    s_waitcnt lgkmcnt(4)
    v_mfma_f32_32x32x16_bf16 v[64:79], a[248:251], a[200:203], v[64:79]
    ds_read_b64_tr_b16 a[244:245], v33 offset:10240
    ds_read_b64_tr_b16 a[246:247], v33 offset:11264
    s_waitcnt vmcnt(5)
    s_waitcnt lgkmcnt(4)
    v_mfma_f32_32x32x16_bf16 v[64:79], a[252:255], a[204:207], v[64:79]
    ds_read_b64_tr_b16 a[248:249], v33 offset:12288
    ds_read_b64_tr_b16 a[250:251], v33 offset:13312
    s_waitcnt vmcnt(4)
    s_waitcnt lgkmcnt(4)
    v_mfma_f32_32x32x16_bf16 v[64:79], a[240:243], a[208:211], v[64:79]
    ds_read_b64_tr_b16 a[252:253], v33 offset:14336
    ds_read_b64_tr_b16 a[254:255], v33 offset:15360
    s_waitcnt vmcnt(3)
    s_waitcnt lgkmcnt(4)
    v_mfma_f32_32x32x16_bf16 v[64:79], a[244:247], a[212:215], v[64:79]
    ds_read_b64_tr_b16 a[240:241], v36 offset:24576
    ds_read_b64_tr_b16 a[242:243], v36 offset:25600
    s_waitcnt vmcnt(2)
    s_waitcnt lgkmcnt(4)
    v_mfma_f32_32x32x16_bf16 v[64:79], a[248:251], a[216:219], v[64:79]
    ds_read_b64_tr_b16 a[244:245], v36 offset:26624
    ds_read_b64_tr_b16 a[246:247], v36 offset:27648
    s_waitcnt vmcnt(0)
    s_waitcnt lgkmcnt(4)
    v_mfma_f32_32x32x16_bf16 v[64:79], a[252:255], a[220:223], v[64:79]
    ds_read_b64_tr_b16 a[248:249], v36 offset:28672
    ds_read_b64_tr_b16 a[250:251], v36 offset:29696
    v_cmp_eq_u32 vcc, s55, v18
    s_nop 3
    s_cmp_eq_u32 vcc_lo, -1
    s_cbranch_scc1 L_poll_ok_7
    s_mov_b32 s62, 0x40000
L_poll_lp_8:
    s_sleep 1
    buffer_load_dword v18, v43, s[44:47], s6 offen offset:0 sc1
    s_waitcnt vmcnt(0)
    s_sub_u32 s62, s62, 1
    s_cmp_eq_u32 s62, 0
    s_cbranch_scc1 L_poll_ok_7
    v_cmp_eq_u32 vcc, s55, v18
    s_nop 3
    s_cmp_eq_u32 vcc_lo, -1
    s_cbranch_scc0 L_poll_lp_8
L_poll_ok_7:
    s_mov_b32 s5, 0
    buffer_load_dwordx4 v[160:163], v38, s[28:31], s5 offen sc1
    s_mov_b32 s5, 8192
    buffer_load_dwordx4 v[164:167], v38, s[28:31], s5 offen sc1
    s_mov_b32 s5, 16384
    buffer_load_dwordx4 v[168:171], v38, s[28:31], s5 offen sc1
    s_mov_b32 s5, 24576
    buffer_load_dwordx4 v[172:175], v38, s[28:31], s5 offen sc1
    s_mov_b32 s5, 32768
    buffer_load_dwordx4 v[176:179], v38, s[28:31], s5 offen sc1
    s_mov_b32 s5, 40960
    buffer_load_dwordx4 v[180:183], v38, s[28:31], s5 offen sc1
    s_mov_b32 s5, 49152
    buffer_load_dwordx4 v[184:187], v38, s[28:31], s5 offen sc1
    s_mov_b32 s5, 57344
    buffer_load_dwordx4 v[188:191], v38, s[28:31], s5 offen sc1
    buffer_load_dword v41, v41, s[36:39], 0 offen sc1
    s_nop 9
    v_cvt_pk_bf16_f32 v208, v64, v65
    v_cvt_pk_bf16_f32 v209, v66, v67
    v_cvt_pk_bf16_f32 v210, v68, v69
    v_mov_b32 v211, v61
    buffer_store_dwordx4 v[208:211], v28, s[32:35], s81 offen sc1
    v_cvt_pk_bf16_f32 v212, v70, v71
    v_cvt_pk_bf16_f32 v213, v72, v73
    v_cvt_pk_bf16_f32 v214, v74, v75
    v_mov_b32 v215, v61
    buffer_store_dwordx4 v[212:215], v28, s[32:35], s81 offen offset:1024 sc1
    v_cvt_pk_bf16_f32 v216, v76, v77
    v_cvt_pk_bf16_f32 v217, v78, v79
    v_mov_b32 v219, v61
    buffer_store_dwordx4 v[216:219], v28, s[32:35], s81 offen offset:2048 sc1
    s_waitcnt lgkmcnt(4)
    v_mfma_f32_32x32x16_bf16 v[80:95], a[240:243], a[112:115], v[80:95]
    ds_read_b64_tr_b16 a[252:253], v36 offset:30720
    ds_read_b64_tr_b16 a[254:255], v36 offset:31744
    s_waitcnt lgkmcnt(4)
    v_mfma_f32_32x32x16_bf16 v[80:95], a[244:247], a[116:119], v[80:95]
    ds_read_b64_tr_b16 a[240:241], v36 offset:32768
    ds_read_b64_tr_b16 a[242:243], v36 offset:33792
    s_waitcnt lgkmcnt(4)
    v_mfma_f32_32x32x16_bf16 v[80:95], a[248:251], a[120:123], v[80:95]
    ds_read_b64_tr_b16 a[244:245], v36 offset:34816
    ds_read_b64_tr_b16 a[246:247], v36 offset:35840
    s_waitcnt lgkmcnt(4)
    v_mfma_f32_32x32x16_bf16 v[80:95], a[252:255], a[124:127], v[80:95]
    ds_read_b64_tr_b16 a[248:249], v36 offset:36864
    ds_read_b64_tr_b16 a[250:251], v36 offset:37888
    s_waitcnt lgkmcnt(4)
    v_mfma_f32_32x32x16_bf16 v[80:95], a[240:243], a[128:131], v[80:95]
    ds_read_b64_tr_b16 a[252:253], v36 offset:38912
    ds_read_b64_tr_b16 a[254:255], v36 offset:39936
    s_waitcnt lgkmcnt(4)
    v_mfma_f32_32x32x16_bf16 v[80:95], a[244:247], a[132:135], v[80:95]
    ds_read_b64_tr_b16 a[240:241], v36 offset:40960
    ds_read_b64_tr_b16 a[242:243], v36 offset:41984
    s_waitcnt lgkmcnt(4)
    v_mfma_f32_32x32x16_bf16 v[80:95], a[248:251], a[136:139], v[80:95]
    ds_read_b64_tr_b16 a[244:245], v36 offset:43008
    ds_read_b64_tr_b16 a[246:247], v36 offset:44032
    s_waitcnt lgkmcnt(4)
    v_mfma_f32_32x32x16_bf16 v[80:95], a[252:255], a[140:143], v[80:95]
    ds_read_b64_tr_b16 a[248:249], v36 offset:45056
    ds_read_b64_tr_b16 a[250:251], v36 offset:46080
    s_waitcnt lgkmcnt(4)
    v_mfma_f32_32x32x16_bf16 v[80:95], a[240:243], a[144:147], v[80:95]
    ds_read_b64_tr_b16 a[252:253], v36 offset:47104
    ds_read_b64_tr_b16 a[254:255], v36 offset:48128
    s_waitcnt lgkmcnt(4)
    v_mfma_f32_32x32x16_bf16 v[80:95], a[244:247], a[148:151], v[80:95]
    ds_read_b64_tr_b16 a[240:241], v35 offset:0
    ds_read_b64_tr_b16 a[242:243], v35 offset:1024
    s_waitcnt lgkmcnt(4)
    v_mfma_f32_32x32x16_bf16 v[80:95], a[248:251], a[152:155], v[80:95]
    ds_read_b64_tr_b16 a[244:245], v35 offset:2048
    ds_read_b64_tr_b16 a[246:247], v35 offset:3072
    s_waitcnt lgkmcnt(4)
    v_mfma_f32_32x32x16_bf16 v[80:95], a[252:255], a[156:159], v[80:95]
    ds_read_b64_tr_b16 a[248:249], v35 offset:4096
    ds_read_b64_tr_b16 a[250:251], v35 offset:5120
    s_waitcnt lgkmcnt(4)
    v_mfma_f32_32x32x16_bf16 v[80:95], a[240:243], a[160:163], v[80:95]
    ds_read_b64_tr_b16 a[252:253], v35 offset:6144
    ds_read_b64_tr_b16 a[254:255], v35 offset:7168
    s_waitcnt lgkmcnt(4)
    v_mfma_f32_32x32x16_bf16 v[80:95], a[244:247], a[164:167], v[80:95]
    ds_read_b64_tr_b16 a[240:241], v35 offset:8192
    ds_read_b64_tr_b16 a[242:243], v35 offset:9216
    s_waitcnt lgkmcnt(4)
    v_mfma_f32_32x32x16_bf16 v[80:95], a[248:251], a[168:171], v[80:95]
    ds_read_b64_tr_b16 a[244:245], v35 offset:10240
    ds_read_b64_tr_b16 a[246:247], v35 offset:11264
    s_waitcnt lgkmcnt(4)
    v_mfma_f32_32x32x16_bf16 v[80:95], a[252:255], a[172:175], v[80:95]
    ds_read_b64_tr_b16 a[248:249], v35 offset:12288
    ds_read_b64_tr_b16 a[250:251], v35 offset:13312
    s_waitcnt lgkmcnt(4)
    v_mfma_f32_32x32x16_bf16 v[80:95], a[240:243], a[176:179], v[80:95]
    ds_read_b64_tr_b16 a[252:253], v35 offset:14336
    ds_read_b64_tr_b16 a[254:255], v35 offset:15360
    s_waitcnt lgkmcnt(4)
    v_mfma_f32_32x32x16_bf16 v[80:95], a[244:247], a[180:183], v[80:95]
    ds_read_b64_tr_b16 a[240:241], v36 offset:0
    ds_read_b64_tr_b16 a[242:243], v36 offset:1024
    s_waitcnt lgkmcnt(4)
    v_mfma_f32_32x32x16_bf16 v[80:95], a[248:251], a[184:187], v[80:95]
    ds_read_b64_tr_b16 a[244:245], v36 offset:2048
    ds_read_b64_tr_b16 a[246:247], v36 offset:3072
    s_waitcnt lgkmcnt(4)
    v_mfma_f32_32x32x16_bf16 v[80:95], a[252:255], a[188:191], v[80:95]
    ds_read_b64_tr_b16 a[248:249], v36 offset:4096
    ds_read_b64_tr_b16 a[250:251], v36 offset:5120
    s_waitcnt lgkmcnt(4)
    v_mfma_f32_32x32x16_bf16 v[80:95], a[240:243], a[192:195], v[80:95]
    ds_read_b64_tr_b16 a[252:253], v36 offset:6144
    ds_read_b64_tr_b16 a[254:255], v36 offset:7168
    s_waitcnt vmcnt(3)
    s_waitcnt lgkmcnt(4)
    v_mfma_f32_32x32x16_bf16 v[80:95], a[244:247], a[196:199], v[80:95]
    ds_read_b64_tr_b16 a[240:241], v36 offset:8192
    ds_read_b64_tr_b16 a[242:243], v36 offset:9216
    s_waitcnt lgkmcnt(4)
    v_mfma_f32_32x32x16_bf16 v[80:95], a[248:251], a[200:203], v[80:95]
    ds_read_b64_tr_b16 a[244:245], v36 offset:10240
    ds_read_b64_tr_b16 a[246:247], v36 offset:11264
    s_waitcnt lgkmcnt(4)
    v_mfma_f32_32x32x16_bf16 v[80:95], a[252:255], a[204:207], v[80:95]
    ds_read_b64_tr_b16 a[248:249], v36 offset:12288
    ds_read_b64_tr_b16 a[250:251], v36 offset:13312
    s_waitcnt lgkmcnt(4)
    v_mfma_f32_32x32x16_bf16 v[80:95], a[240:243], a[208:211], v[80:95]
    ds_read_b64_tr_b16 a[252:253], v36 offset:14336
    ds_read_b64_tr_b16 a[254:255], v36 offset:15360
    s_waitcnt lgkmcnt(4)
    v_mfma_f32_32x32x16_bf16 v[80:95], a[244:247], a[212:215], v[80:95]
    buffer_load_dwordx4 v[208:211], v28, s[32:35], s82 offen sc1
    buffer_load_dwordx4 v[212:215], v28, s[32:35], s82 offen offset:1024 sc1
    buffer_load_dwordx4 v[216:219], v28, s[32:35], s82 offen offset:2048 sc1
    s_waitcnt lgkmcnt(2)
    v_mfma_f32_32x32x16_bf16 v[80:95], a[248:251], a[216:219], v[80:95]
    s_waitcnt lgkmcnt(0)
    v_mfma_f32_32x32x16_bf16 v[80:95], a[252:255], a[220:223], v[80:95]
    v_mul_f32 v41, s54, v41
    v_exp_f32 v41, v41
    s_nop 0
    v_add_f32 v41, 1.0, v41
    v_rcp_f32 v41, v41
    v_mfma_f32_32x32x16_bf16 v[96:111], v[160:163], v[128:131], 0
    v_mfma_f32_32x32x16_bf16 v[96:111], v[164:167], v[132:135], v[96:111]
    v_mfma_f32_32x32x16_bf16 v[96:111], v[168:171], v[136:139], v[96:111]
    v_mfma_f32_32x32x16_bf16 v[96:111], v[172:175], v[140:143], v[96:111]
    v_mfma_f32_32x32x16_bf16 v[96:111], v[176:179], v[144:147], v[96:111]
    v_mfma_f32_32x32x16_bf16 v[96:111], v[180:183], v[148:151], v[96:111]
    v_mfma_f32_32x32x16_bf16 v[96:111], v[184:187], v[152:155], v[96:111]
    v_mfma_f32_32x32x16_bf16 v[96:111], v[188:191], v[156:159], v[96:111]
    v_sub_f32 v48, 1.0, v41
    s_nop 10
    v_sub_f32 v96, v96, v80
    v_sub_f32 v97, v97, v81
    v_sub_f32 v98, v98, v82
    v_sub_f32 v99, v99, v83
    v_sub_f32 v100, v100, v84
    v_sub_f32 v101, v101, v85
    v_sub_f32 v102, v102, v86
    v_sub_f32 v103, v103, v87
    v_sub_f32 v104, v104, v88
    v_sub_f32 v105, v105, v89
    v_sub_f32 v106, v106, v90
    v_sub_f32 v107, v107, v91
    v_sub_f32 v108, v108, v92
    v_sub_f32 v109, v109, v93
    v_sub_f32 v110, v110, v94
    v_sub_f32 v111, v111, v95
    v_fma_f32 v96, v41, v96, v80
    v_fma_f32 v97, v41, v97, v81
    v_fma_f32 v98, v41, v98, v82
    v_fma_f32 v99, v41, v99, v83
    v_fma_f32 v100, v41, v100, v84
    v_fma_f32 v101, v41, v101, v85
    v_fma_f32 v102, v41, v102, v86
    v_fma_f32 v103, v41, v103, v87
    v_fma_f32 v104, v41, v104, v88
    v_fma_f32 v105, v41, v105, v89
    v_fma_f32 v106, v41, v106, v90
    v_fma_f32 v107, v41, v107, v91
    v_fma_f32 v108, v41, v108, v92
    v_fma_f32 v109, v41, v109, v93
    v_fma_f32 v110, v41, v110, v94
    v_fma_f32 v111, v41, v111, v95
    s_waitcnt vmcnt(0)
    v_xor_b32 v192, v211, v61
    v_xor_b32 v193, v215, v61
    v_xor_b32 v194, v219, v61
    v_or3_b32 v192, v192, v193, v194
    v_cmp_ne_u32 vcc, 0, v192
    s_nop 3
    s_cmp_eq_u64 vcc, 0
    s_cbranch_scc1 L_xr_ok_9
    s_mov_b32 s62, 0x40000
L_xr_lp_10:
    s_sleep 1
    buffer_load_dwordx4 v[208:211], v28, s[32:35], s82 offen sc1
    buffer_load_dwordx4 v[212:215], v28, s[32:35], s82 offen offset:1024 sc1
    buffer_load_dwordx4 v[216:219], v28, s[32:35], s82 offen offset:2048 sc1
    s_waitcnt vmcnt(0)
    s_sub_u32 s62, s62, 1
    s_cmp_eq_u32 s62, 0
    s_cbranch_scc1 L_xr_ok_9
    v_xor_b32 v192, v211, v61
    v_xor_b32 v193, v215, v61
    v_xor_b32 v194, v219, v61
    v_or3_b32 v192, v192, v193, v194
    v_cmp_ne_u32 vcc, 0, v192
    s_nop 3
    s_cmp_eq_u64 vcc, 0
    s_cbranch_scc0 L_xr_lp_10
L_xr_ok_9:
    v_lshlrev_b32 v112, 16, v208
    v_and_b32 v113, 0xffff0000, v208
    v_lshlrev_b32 v114, 16, v209
    v_and_b32 v115, 0xffff0000, v209
    v_lshlrev_b32 v116, 16, v210
    v_and_b32 v117, 0xffff0000, v210
    v_lshlrev_b32 v118, 16, v212
    v_and_b32 v119, 0xffff0000, v212
    v_lshlrev_b32 v120, 16, v213
    v_and_b32 v121, 0xffff0000, v213
    v_lshlrev_b32 v122, 16, v214
    v_and_b32 v123, 0xffff0000, v214
    v_lshlrev_b32 v124, 16, v216
    v_and_b32 v125, 0xffff0000, v216
    v_lshlrev_b32 v126, 16, v217
    v_and_b32 v127, 0xffff0000, v217
    v_fma_f32 v96, v48, v112, v96
    v_fma_f32 v97, v48, v113, v97
    v_fma_f32 v98, v48, v114, v98
    v_fma_f32 v99, v48, v115, v99
    v_fma_f32 v100, v48, v116, v100
    v_fma_f32 v101, v48, v117, v101
    v_fma_f32 v102, v48, v118, v102
    v_fma_f32 v103, v48, v119, v103
    v_fma_f32 v104, v48, v120, v104
    v_fma_f32 v105, v48, v121, v105
    v_fma_f32 v106, v48, v122, v106
    v_fma_f32 v107, v48, v123, v107
    v_fma_f32 v108, v48, v124, v108
    v_fma_f32 v109, v48, v125, v109
    v_fma_f32 v110, v48, v126, v110
    v_fma_f32 v111, v48, v127, v111
    v_cvt_pk_bf16_f32 v200, v96, v97
    v_cvt_pk_bf16_f32 v201, v98, v99
    v_cvt_pk_bf16_f32 v202, v100, v101
    v_cvt_pk_bf16_f32 v203, v102, v103
    v_cvt_pk_bf16_f32 v204, v104, v105
    v_cvt_pk_bf16_f32 v205, v106, v107
    v_cvt_pk_bf16_f32 v206, v108, v109
    v_cvt_pk_bf16_f32 v207, v110, v111
    s_nop 1
    v_permlane32_swap_b32 v200, v202
    v_permlane32_swap_b32 v201, v203
    v_permlane32_swap_b32 v204, v206
    v_permlane32_swap_b32 v205, v207
    s_nop 1
    buffer_store_dwordx4 v[200:203], v42, s[40:43], 0 offen offset:0
    buffer_store_dwordx4 v[204:207], v42, s[40:43], 0 offen offset:32
    s_endpgm
L_a1:
    s_lshr_b32 s5, s3, 1
    s_and_b32 s6, s2, 1
    s_lshl_b32 s6, s6, 2
    s_add_u32 s5, s5, s6
    s_and_b32 s6, s3, 1
    s_lshl_b32 s6, s6, 1
    s_lshr_b32 s2, s2, 1
    s_add_u32 s2, s2, s6
    s_mov_b32 s3, s5
    s_add_u32 s99, s2, s3
    s_sub_u32 s62, s99, 7
    s_cselect_b32 s99, s99, s62
    s_lshl_b32 s99, s99, 7
    s_mov_b32 s92, s99
    s_lshl_b32 s5, s2, 2
    s_add_u32 s5, s5, s4
    s_cmp_eq_u32 s5, 15
    s_cselect_b32 s54, 1, 0
    s_cselect_b32 s6, 0, 896
    s_lshl_b32 s5, s5, 4
    s_mul_i32 s8, s5, s6
    s_lshl_b32 s52, s3, 13
    s_lshl_b32 s5, s5, 5
    s_add_u32 s52, s52, s5
    s_lshl_b32 s53, s3, 10
    s_lshl_b32 s5, s3, 3
    s_add_u32 s5, s5, s4
    s_mul_i32 s9, s5, 896
    s_add_u32 s57, s9, 3584
    s_lshl_b32 s56, s2, 3
    s_add_u32 s56, s56, s3
    s_add_u32 s56, s56, 896
    s_lshl_b32 s56, s56, 7
    v_mul_lo_u32 v50, v2, s6
    v_xor_b32 v51, 4, v49
    v_lshl_add_u32 v4, v49, 4, v50
    v_lshl_add_u32 v5, v51, 4, v50
    s_lshl_b32 s5, s6, 3
    v_add_u32 v5, s5, v5
    v_mov_b32 v6, v4
    v_mov_b32 v7, v5
    v_mul_u32_u24 v50, 57344, v2
    v_lshl_add_u32 v8, v49, 4, v50
    v_lshl_add_u32 v51, v51, 4, v50
    v_add_u32 v9, 457728, v51
    v_add_u32 v10, 915456, v8
    v_add_u32 v11, 1373184, v51
    s_cmp_eq_u32 s54, 1
    s_waitcnt lgkmcnt(0)
    s_cselect_b32 s12, s82, s70
    s_cselect_b32 s13, s83, s71
    s_mov_b32 s5, 401408
    s_cselect_b32 s14, 896, s5
    s_mov_b32 s15, 0x20000
    s_cselect_b32 s16, s82, s72
    s_cselect_b32 s17, s83, s73
    s_cselect_b32 s18, 896, s5
    s_mov_b32 s19, 0x20000
    s_mov_b32 s20, s64
    s_mov_b32 s21, s65
    s_mov_b32 s22, 1835008
    s_mov_b32 s23, 0x20000
    s_mov_b32 s48, s86
    s_mov_b32 s49, s87
    s_mov_b32 s50, 256
    s_mov_b32 s51, 0x20000
    s_or_b32 s5, s63, s4
    s_cmp_lg_u32 s5, 0
    s_cbranch_scc1 L_notok_11
    s_memrealtime s[6:7]
    s_waitcnt lgkmcnt(0)
    s_and_b32 s6, s6, 0xffffff00
    s_or_b32 s6, s6, 0x40
    v_mov_b32 v18, s6
    buffer_store_dword v18, off, s[48:51], 0 sc1
L_notok_11:
    s_add_u32 m0, s10, 0
    s_add_u32 s74, s8, s92
    buffer_load_dwordx4 v4, s[12:15], s74 offen lds
    s_add_u32 m0, s10, 1024
    s_nop 0
    buffer_load_dwordx4 v5, s[12:15], s74 offen lds
    s_add_u32 m0, s10, 2048
    s_nop 0
    buffer_load_dwordx4 v6, s[16:19], s74 offen lds
    s_add_u32 m0, s10, 3072
    s_nop 0
    buffer_load_dwordx4 v7, s[16:19], s74 offen lds
    s_add_u32 m0, s11, 0
    s_add_u32 s75, s92, s9
    buffer_load_dwordx4 v8, s[20:23], s75 offen lds
    buffer_load_dwordx4 v9, s[20:23], s75 offen offset:1024 lds
    buffer_load_dwordx4 v10, s[20:23], s75 offen offset:2048 lds
    buffer_load_dwordx4 v11, s[20:23], s75 offen offset:3072 lds
    s_add_u32 s92, s99, 0
    s_sub_u32 s62, s92, 896
    s_cselect_b32 s92, s92, s62
    s_add_u32 s93, s99, 128
    s_sub_u32 s62, s93, 896
    s_cselect_b32 s93, s93, s62
    s_add_u32 s94, s99, 256
    s_sub_u32 s62, s94, 896
    s_cselect_b32 s94, s94, s62
    s_add_u32 s95, s99, 384
    s_sub_u32 s62, s95, 896
    s_cselect_b32 s95, s95, s62
    s_add_u32 s96, s99, 512
    s_sub_u32 s62, s96, 896
    s_cselect_b32 s96, s96, s62
    s_add_u32 s97, s99, 640
    s_sub_u32 s62, s97, 896
    s_cselect_b32 s97, s97, s62
    s_add_u32 s98, s99, 768
    s_sub_u32 s62, s98, 896
    s_cselect_b32 s98, s98, s62
    v_and_b32 v2, 31, v1
    v_lshrrev_b32 v3, 5, v1
    v_bfe_u32 v48, v2, 1, 3
    v_xor_b32 v48, v48, v3
    v_lshlrev_b32 v48, 4, v48
    v_lshl_add_u32 v12, v2, 7, v48
    v_xor_b32 v13, 32, v12
    v_xor_b32 v14, 64, v12
    v_xor_b32 v15, 96, v12
    v_add_u32 v20, s10, v12
    v_add_u32 v21, s10, v13
    v_add_u32 v22, s10, v14
    v_add_u32 v23, s10, v15
    v_add_u32 v24, 65536, v20
    v_add_u32 v25, 65536, v21
    v_add_u32 v26, 65536, v22
    v_add_u32 v27, 65536, v23
    v_add_u32 v30, 65536, v12
    v_add_u32 v31, 65536, v13
    v_add_u32 v32, 65536, v14
    v_add_u32 v33, 65536, v15
    s_add_u32 m0, s11, 16384
    s_add_u32 s75, s93, s9
    buffer_load_dwordx4 v8, s[20:23], s75 offen lds
    buffer_load_dwordx4 v9, s[20:23], s75 offen offset:1024 lds
    s_add_u32 s24, s88, 8388608
    s_addc_u32 s25, s89, 0
    s_mov_b32 s26, 2097152
    s_mov_b32 s27, 0x20000
    buffer_load_dwordx4 v10, s[20:23], s75 offen offset:2048 lds
    buffer_load_dwordx4 v11, s[20:23], s75 offen offset:3072 lds
    s_add_u32 s36, s88, 10485760
    s_addc_u32 s37, s89, 0
    s_mov_b32 s38, 8192
    s_mov_b32 s39, 0x20000
    s_add_u32 m0, s10, 16384
    s_add_u32 s74, s8, s93
    buffer_load_dwordx4 v4, s[12:15], s74 offen lds
    s_add_u32 m0, s10, 17408
    s_nop 0
    buffer_load_dwordx4 v5, s[12:15], s74 offen lds
    s_add_u32 s44, s88, 11534336
    s_addc_u32 s45, s89, 0
    s_mov_b32 s46, 245760
    s_mov_b32 s47, 0x20000
    s_add_u32 m0, s10, 18432
    s_nop 0
    buffer_load_dwordx4 v6, s[16:19], s74 offen lds
    s_add_u32 m0, s10, 19456
    s_nop 0
    buffer_load_dwordx4 v7, s[16:19], s74 offen lds
    v_and_b32 v2, 31, v1
    v_lshrrev_b32 v3, 5, v1
    v_cvt_f32_u32 v48, v2
    v_mul_f32 v48, 0x3d000000, v48
    v_cvt_f32_u32 v49, v3
    v_mul_f32 v49, 4.0, v49
    v_mul_f32 v49, v49, v48
    s_mov_b32 s5, 0x0
    v_fma_f32 v50, s5, v48, v49
    s_mov_b32 s5, 0x3f800000
    v_fma_f32 v51, s5, v48, v49
    v_add_f32 v52, 0x3e800000, v50
    v_add_f32 v53, 0x3e800000, v51
    v_cos_f32 v54, v50
    v_cos_f32 v55, v51
    v_cos_f32 v56, v52
    v_cos_f32 v57, v53
    s_nop 0
    v_cvt_pk_bf16_f32 v58, v54, v55
    v_cvt_pk_bf16_f32 v59, v56, v57
    v_accvgpr_write_b32 a144, v58
    v_accvgpr_write_b32 a152, v59
    s_mov_b32 s5, 0x40000000
    v_fma_f32 v50, s5, v48, v49
    s_mov_b32 s5, 0x40400000
    v_fma_f32 v51, s5, v48, v49
    v_add_f32 v52, 0x3e800000, v50
    v_add_f32 v53, 0x3e800000, v51
    v_cos_f32 v54, v50
    v_cos_f32 v55, v51
    v_cos_f32 v56, v52
    v_cos_f32 v57, v53
    s_nop 0
    v_cvt_pk_bf16_f32 v58, v54, v55
    v_cvt_pk_bf16_f32 v59, v56, v57
    v_accvgpr_write_b32 a145, v58
    v_accvgpr_write_b32 a153, v59
    s_mov_b32 s5, 0x41000000
    v_fma_f32 v50, s5, v48, v49
    s_mov_b32 s5, 0x41100000
    v_fma_f32 v51, s5, v48, v49
    v_add_f32 v52, 0x3e800000, v50
    v_add_f32 v53, 0x3e800000, v51
    v_cos_f32 v54, v50
    v_cos_f32 v55, v51
    v_cos_f32 v56, v52
    v_cos_f32 v57, v53
    s_nop 0
    v_cvt_pk_bf16_f32 v58, v54, v55
    v_cvt_pk_bf16_f32 v59, v56, v57
    v_accvgpr_write_b32 a146, v58
    v_accvgpr_write_b32 a154, v59
    s_mov_b32 s5, 0x41200000
    v_fma_f32 v50, s5, v48, v49
    s_mov_b32 s5, 0x41300000
    v_fma_f32 v51, s5, v48, v49
    v_add_f32 v52, 0x3e800000, v50
    v_add_f32 v53, 0x3e800000, v51
    v_cos_f32 v54, v50
    v_cos_f32 v55, v51
    v_cos_f32 v56, v52
    v_cos_f32 v57, v53
    s_nop 0
    v_cvt_pk_bf16_f32 v58, v54, v55
    v_cvt_pk_bf16_f32 v59, v56, v57
    v_accvgpr_write_b32 a147, v58
    v_accvgpr_write_b32 a155, v59
    s_mov_b32 s5, 0x41800000
    v_fma_f32 v50, s5, v48, v49
    s_mov_b32 s5, 0x41880000
    v_fma_f32 v51, s5, v48, v49
    v_add_f32 v52, 0x3e800000, v50
    v_add_f32 v53, 0x3e800000, v51
    v_cos_f32 v54, v50
    v_cos_f32 v55, v51
    v_cos_f32 v56, v52
    v_cos_f32 v57, v53
    s_nop 0
    v_cvt_pk_bf16_f32 v58, v54, v55
    v_cvt_pk_bf16_f32 v59, v56, v57
    v_accvgpr_write_b32 a148, v58
    v_accvgpr_write_b32 a156, v59
    s_mov_b32 s5, 0x41900000
    v_fma_f32 v50, s5, v48, v49
    s_mov_b32 s5, 0x41980000
    v_fma_f32 v51, s5, v48, v49
    v_add_f32 v52, 0x3e800000, v50
    v_add_f32 v53, 0x3e800000, v51
    v_cos_f32 v54, v50
    v_cos_f32 v55, v51
    v_cos_f32 v56, v52
    v_cos_f32 v57, v53
    s_nop 0
    v_cvt_pk_bf16_f32 v58, v54, v55
    v_cvt_pk_bf16_f32 v59, v56, v57
    v_accvgpr_write_b32 a149, v58
    v_accvgpr_write_b32 a157, v59
    s_mov_b32 s5, 0x41c00000
    v_fma_f32 v50, s5, v48, v49
    s_mov_b32 s5, 0x41c80000
    v_fma_f32 v51, s5, v48, v49
    v_add_f32 v52, 0x3e800000, v50
    v_add_f32 v53, 0x3e800000, v51
    v_cos_f32 v54, v50
    v_cos_f32 v55, v51
    v_cos_f32 v56, v52
    v_cos_f32 v57, v53
    s_nop 0
    v_cvt_pk_bf16_f32 v58, v54, v55
    v_cvt_pk_bf16_f32 v59, v56, v57
    v_accvgpr_write_b32 a150, v58
    v_accvgpr_write_b32 a158, v59
    s_mov_b32 s5, 0x41d00000
    v_fma_f32 v50, s5, v48, v49
    s_mov_b32 s5, 0x41d80000
    v_fma_f32 v51, s5, v48, v49
    v_add_f32 v52, 0x3e800000, v50
    v_add_f32 v53, 0x3e800000, v51
    v_cos_f32 v54, v50
    v_cos_f32 v55, v51
    v_cos_f32 v56, v52
    v_cos_f32 v57, v53
    s_nop 0
    v_cvt_pk_bf16_f32 v58, v54, v55
    v_cvt_pk_bf16_f32 v59, v56, v57
    v_accvgpr_write_b32 a151, v58
    v_accvgpr_write_b32 a159, v59
    v_mul_u32_u24 v28, 528, v2
    v_lshl_add_u32 v28, v3, 7, v28
    s_mul_i32 s5, s4, 16896
    v_add_u32 v28, s5, v28
    v_lshlrev_b32 v29, 4, v3
    s_waitcnt vmcnt(8)
    s_barrier
    ds_read_b128 a[0:3], v20 offset:0
    ds_read_b128 a[112:115], v12 offset:0
    ds_read_b128 a[116:119], v12 offset:4096
    ds_read_b128 a[120:123], v12 offset:8192
    ds_read_b128 a[124:127], v12 offset:12288
    s_waitcnt lgkmcnt(2)
    v_mfma_f32_32x32x16_bf16 v[64:79], a[112:115], a[0:3], 0
    ds_read_b128 a[4:7], v21 offset:0
    ds_read_b128 a[128:131], v13 offset:0
    ds_read_b128 a[132:135], v13 offset:4096
    v_mfma_f32_32x32x16_bf16 v[80:95], a[116:119], a[0:3], 0
    s_waitcnt lgkmcnt(3)
    v_mfma_f32_32x32x16_bf16 v[96:111], a[120:123], a[0:3], 0
    ds_read_b128 a[136:139], v13 offset:8192
    ds_read_b128 a[140:143], v13 offset:12288
    v_mfma_f32_32x32x16_bf16 v[112:127], a[124:127], a[0:3], 0
    s_waitcnt lgkmcnt(2)
    v_mfma_f32_32x32x16_bf16 v[64:79], a[128:131], a[4:7], v[64:79]
    ds_read_b128 a[8:11], v22 offset:0
    ds_read_b128 a[112:115], v14 offset:0
    ds_read_b128 a[116:119], v14 offset:4096
    s_add_u32 m0, s10, 32768
    s_add_u32 s74, s8, s94
    buffer_load_dwordx4 v4, s[12:15], s74 offen lds
    v_mfma_f32_32x32x16_bf16 v[80:95], a[132:135], a[4:7], v[80:95]
    s_add_u32 m0, s10, 33792
    s_nop 0
    buffer_load_dwordx4 v5, s[12:15], s74 offen lds
    s_waitcnt lgkmcnt(3)
    v_mfma_f32_32x32x16_bf16 v[96:111], a[136:139], a[4:7], v[96:111]
    ds_read_b128 a[120:123], v14 offset:8192
    ds_read_b128 a[124:127], v14 offset:12288
    s_add_u32 m0, s10, 34816
    s_nop 0
    buffer_load_dwordx4 v6, s[16:19], s74 offen lds
    v_mfma_f32_32x32x16_bf16 v[112:127], a[140:143], a[4:7], v[112:127]
    s_add_u32 m0, s10, 35840
    s_nop 0
    buffer_load_dwordx4 v7, s[16:19], s74 offen lds
    s_waitcnt lgkmcnt(2)
    v_mfma_f32_32x32x16_bf16 v[64:79], a[112:115], a[8:11], v[64:79]
    ds_read_b128 a[12:15], v23 offset:0
    ds_read_b128 a[128:131], v15 offset:0
    ds_read_b128 a[132:135], v15 offset:4096
    s_add_u32 m0, s11, 32768
    s_add_u32 s75, s94, s9
    buffer_load_dwordx4 v8, s[20:23], s75 offen lds
    v_mfma_f32_32x32x16_bf16 v[80:95], a[116:119], a[8:11], v[80:95]
    buffer_load_dwordx4 v9, s[20:23], s75 offen offset:1024 lds
    s_waitcnt lgkmcnt(3)
    v_mfma_f32_32x32x16_bf16 v[96:111], a[120:123], a[8:11], v[96:111]
    ds_read_b128 a[136:139], v15 offset:8192
    ds_read_b128 a[140:143], v15 offset:12288
    buffer_load_dwordx4 v10, s[20:23], s75 offen offset:2048 lds
    v_mfma_f32_32x32x16_bf16 v[112:127], a[124:127], a[8:11], v[112:127]
    buffer_load_dwordx4 v11, s[20:23], s75 offen offset:3072 lds
    s_waitcnt vmcnt(8)
    s_barrier
    s_waitcnt lgkmcnt(2)
    v_mfma_f32_32x32x16_bf16 v[64:79], a[128:131], a[12:15], v[64:79]
    ds_read_b128 a[16:19], v20 offset:16384
    ds_read_b128 a[112:115], v12 offset:16384
    ds_read_b128 a[116:119], v12 offset:20480
    s_add_u32 m0, s10, 49152
    s_add_u32 s74, s8, s95
    buffer_load_dwordx4 v4, s[12:15], s74 offen lds
    v_mfma_f32_32x32x16_bf16 v[80:95], a[132:135], a[12:15], v[80:95]
    s_waitcnt lgkmcnt(3)
    v_mfma_f32_32x32x16_bf16 v[96:111], a[136:139], a[12:15], v[96:111]
    ds_read_b128 a[120:123], v12 offset:24576
    ds_read_b128 a[124:127], v12 offset:28672
    s_add_u32 m0, s10, 50176
    s_nop 0
    buffer_load_dwordx4 v5, s[12:15], s74 offen lds
    v_mfma_f32_32x32x16_bf16 v[112:127], a[140:143], a[12:15], v[112:127]
    s_waitcnt lgkmcnt(2)
    v_mfma_f32_32x32x16_bf16 v[64:79], a[112:115], a[16:19], v[64:79]
    ds_read_b128 a[20:23], v21 offset:16384
    ds_read_b128 a[128:131], v13 offset:16384
    ds_read_b128 a[132:135], v13 offset:20480
    s_add_u32 m0, s10, 51200
    s_nop 0
    buffer_load_dwordx4 v6, s[16:19], s74 offen lds
    v_mfma_f32_32x32x16_bf16 v[80:95], a[116:119], a[16:19], v[80:95]
    s_waitcnt lgkmcnt(3)
    v_mfma_f32_32x32x16_bf16 v[96:111], a[120:123], a[16:19], v[96:111]
    ds_read_b128 a[136:139], v13 offset:24576
    ds_read_b128 a[140:143], v13 offset:28672
    s_add_u32 m0, s10, 52224
    s_nop 0
    buffer_load_dwordx4 v7, s[16:19], s74 offen lds
    v_mfma_f32_32x32x16_bf16 v[112:127], a[124:127], a[16:19], v[112:127]
    s_waitcnt lgkmcnt(2)
    v_mfma_f32_32x32x16_bf16 v[64:79], a[128:131], a[20:23], v[64:79]
    ds_read_b128 a[24:27], v22 offset:16384
    ds_read_b128 a[112:115], v14 offset:16384
    ds_read_b128 a[116:119], v14 offset:20480
    s_add_u32 m0, s11, 49152
    s_add_u32 s75, s95, s9
    buffer_load_dwordx4 v8, s[20:23], s75 offen lds
    v_mfma_f32_32x32x16_bf16 v[80:95], a[132:135], a[20:23], v[80:95]
    s_waitcnt lgkmcnt(3)
    v_mfma_f32_32x32x16_bf16 v[96:111], a[136:139], a[20:23], v[96:111]
    ds_read_b128 a[120:123], v14 offset:24576
    ds_read_b128 a[124:127], v14 offset:28672
    buffer_load_dwordx4 v9, s[20:23], s75 offen offset:1024 lds
    v_mfma_f32_32x32x16_bf16 v[112:127], a[140:143], a[20:23], v[112:127]
    s_waitcnt lgkmcnt(2)
    v_mfma_f32_32x32x16_bf16 v[64:79], a[112:115], a[24:27], v[64:79]
    ds_read_b128 a[28:31], v23 offset:16384
    ds_read_b128 a[128:131], v15 offset:16384
    ds_read_b128 a[132:135], v15 offset:20480
    buffer_load_dwordx4 v10, s[20:23], s75 offen offset:2048 lds
    v_mfma_f32_32x32x16_bf16 v[80:95], a[116:119], a[24:27], v[80:95]
    s_waitcnt lgkmcnt(3)
    v_mfma_f32_32x32x16_bf16 v[96:111], a[120:123], a[24:27], v[96:111]
    ds_read_b128 a[136:139], v15 offset:24576
    ds_read_b128 a[140:143], v15 offset:28672
    buffer_load_dwordx4 v11, s[20:23], s75 offen offset:3072 lds
    v_mfma_f32_32x32x16_bf16 v[112:127], a[124:127], a[24:27], v[112:127]
    s_waitcnt vmcnt(8)
    s_barrier
    s_waitcnt lgkmcnt(2)
    v_mfma_f32_32x32x16_bf16 v[64:79], a[128:131], a[28:31], v[64:79]
    ds_read_b128 a[32:35], v20 offset:32768
    ds_read_b128 a[112:115], v12 offset:32768
    ds_read_b128 a[116:119], v12 offset:36864
    s_add_u32 m0, s10, 65536
    s_add_u32 s74, s8, s96
    buffer_load_dwordx4 v4, s[12:15], s74 offen lds
    v_mfma_f32_32x32x16_bf16 v[80:95], a[132:135], a[28:31], v[80:95]
    s_waitcnt lgkmcnt(3)
    v_mfma_f32_32x32x16_bf16 v[96:111], a[136:139], a[28:31], v[96:111]
    ds_read_b128 a[120:123], v12 offset:40960
    ds_read_b128 a[124:127], v12 offset:45056
    s_add_u32 m0, s10, 66560
    s_nop 0
    buffer_load_dwordx4 v5, s[12:15], s74 offen lds
    v_mfma_f32_32x32x16_bf16 v[112:127], a[140:143], a[28:31], v[112:127]
    s_waitcnt lgkmcnt(2)
    v_mfma_f32_32x32x16_bf16 v[64:79], a[112:115], a[32:35], v[64:79]
    ds_read_b128 a[36:39], v21 offset:32768
    ds_read_b128 a[128:131], v13 offset:32768
    ds_read_b128 a[132:135], v13 offset:36864
    s_add_u32 m0, s10, 67584
    s_nop 0
    buffer_load_dwordx4 v6, s[16:19], s74 offen lds
    v_mfma_f32_32x32x16_bf16 v[80:95], a[116:119], a[32:35], v[80:95]
    s_waitcnt lgkmcnt(3)
    v_mfma_f32_32x32x16_bf16 v[96:111], a[120:123], a[32:35], v[96:111]
    ds_read_b128 a[136:139], v13 offset:40960
    ds_read_b128 a[140:143], v13 offset:45056
    s_add_u32 m0, s10, 68608
    s_nop 0
    buffer_load_dwordx4 v7, s[16:19], s74 offen lds
    v_mfma_f32_32x32x16_bf16 v[112:127], a[124:127], a[32:35], v[112:127]
    s_waitcnt lgkmcnt(2)
    v_mfma_f32_32x32x16_bf16 v[64:79], a[128:131], a[36:39], v[64:79]
    ds_read_b128 a[40:43], v22 offset:32768
    ds_read_b128 a[112:115], v14 offset:32768
    ds_read_b128 a[116:119], v14 offset:36864
    s_add_u32 m0, s11, 65536
    s_add_u32 s75, s96, s9
    buffer_load_dwordx4 v8, s[20:23], s75 offen lds
    v_mfma_f32_32x32x16_bf16 v[80:95], a[132:135], a[36:39], v[80:95]
    s_waitcnt lgkmcnt(3)
    v_mfma_f32_32x32x16_bf16 v[96:111], a[136:139], a[36:39], v[96:111]
    ds_read_b128 a[120:123], v14 offset:40960
    ds_read_b128 a[124:127], v14 offset:45056
    buffer_load_dwordx4 v9, s[20:23], s75 offen offset:1024 lds
    v_mfma_f32_32x32x16_bf16 v[112:127], a[140:143], a[36:39], v[112:127]
    s_waitcnt lgkmcnt(2)
    v_mfma_f32_32x32x16_bf16 v[64:79], a[112:115], a[40:43], v[64:79]
    ds_read_b128 a[44:47], v23 offset:32768
    ds_read_b128 a[128:131], v15 offset:32768
    ds_read_b128 a[132:135], v15 offset:36864
    buffer_load_dwordx4 v10, s[20:23], s75 offen offset:2048 lds
    v_mfma_f32_32x32x16_bf16 v[80:95], a[116:119], a[40:43], v[80:95]
    s_waitcnt lgkmcnt(3)
    v_mfma_f32_32x32x16_bf16 v[96:111], a[120:123], a[40:43], v[96:111]
    ds_read_b128 a[136:139], v15 offset:40960
    ds_read_b128 a[140:143], v15 offset:45056
    buffer_load_dwordx4 v11, s[20:23], s75 offen offset:3072 lds
    v_mfma_f32_32x32x16_bf16 v[112:127], a[124:127], a[40:43], v[112:127]
    s_waitcnt vmcnt(8)
    s_barrier
    s_waitcnt lgkmcnt(2)
    v_mfma_f32_32x32x16_bf16 v[64:79], a[128:131], a[44:47], v[64:79]
    ds_read_b128 a[48:51], v20 offset:49152
    ds_read_b128 a[112:115], v12 offset:49152
    ds_read_b128 a[116:119], v12 offset:53248
    buffer_load_dword v18, off, s[48:51], 0 sc1
    s_add_u32 m0, s10, 0
    s_add_u32 s74, s8, s97
    buffer_load_dwordx4 v4, s[12:15], s74 offen lds
    v_mfma_f32_32x32x16_bf16 v[80:95], a[132:135], a[44:47], v[80:95]
    s_waitcnt lgkmcnt(3)
    v_mfma_f32_32x32x16_bf16 v[96:111], a[136:139], a[44:47], v[96:111]
    ds_read_b128 a[120:123], v12 offset:57344
    ds_read_b128 a[124:127], v12 offset:61440
    s_add_u32 m0, s10, 1024
    s_nop 0
    buffer_load_dwordx4 v5, s[12:15], s74 offen lds
    v_mfma_f32_32x32x16_bf16 v[112:127], a[140:143], a[44:47], v[112:127]
    s_waitcnt lgkmcnt(2)
    v_mfma_f32_32x32x16_bf16 v[64:79], a[112:115], a[48:51], v[64:79]
    ds_read_b128 a[52:55], v21 offset:49152
    ds_read_b128 a[128:131], v13 offset:49152
    ds_read_b128 a[132:135], v13 offset:53248
    s_add_u32 m0, s10, 2048
    s_nop 0
    buffer_load_dwordx4 v6, s[16:19], s74 offen lds
    v_mfma_f32_32x32x16_bf16 v[80:95], a[116:119], a[48:51], v[80:95]
    s_waitcnt lgkmcnt(3)
    v_mfma_f32_32x32x16_bf16 v[96:111], a[120:123], a[48:51], v[96:111]
    ds_read_b128 a[136:139], v13 offset:57344
    ds_read_b128 a[140:143], v13 offset:61440
    s_add_u32 m0, s10, 3072
    s_nop 0
    buffer_load_dwordx4 v7, s[16:19], s74 offen lds
    v_mfma_f32_32x32x16_bf16 v[112:127], a[124:127], a[48:51], v[112:127]
    s_waitcnt lgkmcnt(2)
    v_mfma_f32_32x32x16_bf16 v[64:79], a[128:131], a[52:55], v[64:79]
    ds_read_b128 a[56:59], v22 offset:49152
    ds_read_b128 a[112:115], v14 offset:49152
    ds_read_b128 a[116:119], v14 offset:53248
    s_add_u32 m0, s11, 0
    s_add_u32 s75, s97, s9
    buffer_load_dwordx4 v8, s[20:23], s75 offen lds
    v_mfma_f32_32x32x16_bf16 v[80:95], a[132:135], a[52:55], v[80:95]
    s_waitcnt lgkmcnt(3)
    v_mfma_f32_32x32x16_bf16 v[96:111], a[136:139], a[52:55], v[96:111]
    ds_read_b128 a[120:123], v14 offset:57344
    ds_read_b128 a[124:127], v14 offset:61440
    buffer_load_dwordx4 v9, s[20:23], s75 offen offset:1024 lds
    v_mfma_f32_32x32x16_bf16 v[112:127], a[140:143], a[52:55], v[112:127]
    s_waitcnt lgkmcnt(2)
    v_mfma_f32_32x32x16_bf16 v[64:79], a[112:115], a[56:59], v[64:79]
    ds_read_b128 a[60:63], v23 offset:49152
    ds_read_b128 a[128:131], v15 offset:49152
    ds_read_b128 a[132:135], v15 offset:53248
    buffer_load_dwordx4 v10, s[20:23], s75 offen offset:2048 lds
    v_mfma_f32_32x32x16_bf16 v[80:95], a[116:119], a[56:59], v[80:95]
    s_waitcnt lgkmcnt(3)
    v_mfma_f32_32x32x16_bf16 v[96:111], a[120:123], a[56:59], v[96:111]
    ds_read_b128 a[136:139], v15 offset:57344
    ds_read_b128 a[140:143], v15 offset:61440
    buffer_load_dwordx4 v11, s[20:23], s75 offen offset:3072 lds
    v_mfma_f32_32x32x16_bf16 v[112:127], a[124:127], a[56:59], v[112:127]
    s_waitcnt vmcnt(9)
    s_barrier
    s_waitcnt lgkmcnt(2)
    v_mfma_f32_32x32x16_bf16 v[64:79], a[128:131], a[60:63], v[64:79]
    ds_read_b128 a[64:67], v24 offset:0
    ds_read_b128 a[112:115], v30 offset:0
    ds_read_b128 a[116:119], v30 offset:4096
    s_waitcnt vmcnt(8)
    v_readfirstlane_b32 s55, v18
    s_nop 3
    s_cmp_lg_u32 s55, 0
    s_cbranch_scc1 L_tok_ok_12
    s_mov_b32 s62, 0x40000
L_tok_lp_13:
    s_sleep 2
    buffer_load_dword v18, off, s[48:51], 0 sc1
    s_waitcnt vmcnt(0)
    v_readfirstlane_b32 s55, v18
    s_sub_u32 s62, s62, 1
    s_cmp_eq_u32 s62, 0
    s_cbranch_scc1 L_tok_ok_12
    s_cmp_eq_u32 s55, 0
    s_cbranch_scc1 L_tok_lp_13
L_tok_ok_12:
    v_mov_b32 v61, s55
    s_add_u32 m0, s10, 16384
    s_add_u32 s74, s8, s98
    buffer_load_dwordx4 v4, s[12:15], s74 offen lds
    v_mfma_f32_32x32x16_bf16 v[80:95], a[132:135], a[60:63], v[80:95]
    s_waitcnt lgkmcnt(3)
    v_mfma_f32_32x32x16_bf16 v[96:111], a[136:139], a[60:63], v[96:111]
    ds_read_b128 a[120:123], v30 offset:8192
    ds_read_b128 a[124:127], v30 offset:12288
    s_add_u32 m0, s10, 17408
    s_nop 0
    buffer_load_dwordx4 v5, s[12:15], s74 offen lds
    v_mfma_f32_32x32x16_bf16 v[112:127], a[140:143], a[60:63], v[112:127]
    s_waitcnt lgkmcnt(2)
    v_mfma_f32_32x32x16_bf16 v[64:79], a[112:115], a[64:67], v[64:79]
    ds_read_b128 a[68:71], v25 offset:0
    ds_read_b128 a[128:131], v31 offset:0
    ds_read_b128 a[132:135], v31 offset:4096
    s_add_u32 m0, s10, 18432
    s_nop 0
    buffer_load_dwordx4 v6, s[16:19], s74 offen lds
    v_mfma_f32_32x32x16_bf16 v[80:95], a[116:119], a[64:67], v[80:95]
    s_waitcnt lgkmcnt(3)
    v_mfma_f32_32x32x16_bf16 v[96:111], a[120:123], a[64:67], v[96:111]
    ds_read_b128 a[136:139], v31 offset:8192
    ds_read_b128 a[140:143], v31 offset:12288
    s_add_u32 m0, s10, 19456
    s_nop 0
    buffer_load_dwordx4 v7, s[16:19], s74 offen lds
    v_mfma_f32_32x32x16_bf16 v[112:127], a[124:127], a[64:67], v[112:127]
    s_waitcnt lgkmcnt(2)
    v_mfma_f32_32x32x16_bf16 v[64:79], a[128:131], a[68:71], v[64:79]
    ds_read_b128 a[72:75], v26 offset:0
    ds_read_b128 a[112:115], v32 offset:0
    ds_read_b128 a[116:119], v32 offset:4096
    s_add_u32 m0, s11, 16384
    s_add_u32 s75, s98, s9
    buffer_load_dwordx4 v8, s[20:23], s75 offen lds
    v_mfma_f32_32x32x16_bf16 v[80:95], a[132:135], a[68:71], v[80:95]
    s_waitcnt lgkmcnt(3)
    v_mfma_f32_32x32x16_bf16 v[96:111], a[136:139], a[68:71], v[96:111]
    ds_read_b128 a[120:123], v32 offset:8192
    ds_read_b128 a[124:127], v32 offset:12288
    buffer_load_dwordx4 v9, s[20:23], s75 offen offset:1024 lds
    v_mfma_f32_32x32x16_bf16 v[112:127], a[140:143], a[68:71], v[112:127]
    s_waitcnt lgkmcnt(2)
    v_mfma_f32_32x32x16_bf16 v[64:79], a[112:115], a[72:75], v[64:79]
    ds_read_b128 a[76:79], v27 offset:0
    ds_read_b128 a[128:131], v33 offset:0
    ds_read_b128 a[132:135], v33 offset:4096
    buffer_load_dwordx4 v10, s[20:23], s75 offen offset:2048 lds
    v_mfma_f32_32x32x16_bf16 v[80:95], a[116:119], a[72:75], v[80:95]
    s_waitcnt lgkmcnt(3)
    v_mfma_f32_32x32x16_bf16 v[96:111], a[120:123], a[72:75], v[96:111]
    ds_read_b128 a[136:139], v33 offset:8192
    ds_read_b128 a[140:143], v33 offset:12288
    buffer_load_dwordx4 v11, s[20:23], s75 offen offset:3072 lds
    v_mfma_f32_32x32x16_bf16 v[112:127], a[124:127], a[72:75], v[112:127]
    s_waitcnt vmcnt(8)
    s_barrier
    s_waitcnt lgkmcnt(2)
    v_mfma_f32_32x32x16_bf16 v[64:79], a[128:131], a[76:79], v[64:79]
    ds_read_b128 a[80:83], v20 offset:0
    ds_read_b128 a[112:115], v12 offset:0
    ds_read_b128 a[116:119], v12 offset:4096
    s_add_u32 m0, s11, 32768
    s_add_u32 s75, s92, s57
    buffer_load_dwordx4 v8, s[20:23], s75 offen lds
    v_mfma_f32_32x32x16_bf16 v[80:95], a[132:135], a[76:79], v[80:95]
    s_waitcnt lgkmcnt(3)
    v_mfma_f32_32x32x16_bf16 v[96:111], a[136:139], a[76:79], v[96:111]
    ds_read_b128 a[120:123], v12 offset:8192
    ds_read_b128 a[124:127], v12 offset:12288
    v_mfma_f32_32x32x16_bf16 v[112:127], a[140:143], a[76:79], v[112:127]
    s_waitcnt lgkmcnt(2)
    v_mfma_f32_32x32x16_bf16 v[64:79], a[112:115], a[80:83], v[64:79]
    ds_read_b128 a[84:87], v21 offset:0
    ds_read_b128 a[128:131], v13 offset:0
    ds_read_b128 a[132:135], v13 offset:4096
    buffer_load_dwordx4 v9, s[20:23], s75 offen offset:1024 lds
    v_mfma_f32_32x32x16_bf16 v[80:95], a[116:119], a[80:83], v[80:95]
    s_waitcnt lgkmcnt(3)
    v_mfma_f32_32x32x16_bf16 v[96:111], a[120:123], a[80:83], v[96:111]
    ds_read_b128 a[136:139], v13 offset:8192
    ds_read_b128 a[140:143], v13 offset:12288
    v_mfma_f32_32x32x16_bf16 v[112:127], a[124:127], a[80:83], v[112:127]
    s_waitcnt lgkmcnt(2)
    v_mfma_f32_32x32x16_bf16 v[64:79], a[128:131], a[84:87], v[64:79]
    ds_read_b128 a[88:91], v22 offset:0
    ds_read_b128 a[112:115], v14 offset:0
    ds_read_b128 a[116:119], v14 offset:4096
    buffer_load_dwordx4 v10, s[20:23], s75 offen offset:2048 lds
    v_mfma_f32_32x32x16_bf16 v[80:95], a[132:135], a[84:87], v[80:95]
    s_waitcnt lgkmcnt(3)
    v_mfma_f32_32x32x16_bf16 v[96:111], a[136:139], a[84:87], v[96:111]
    ds_read_b128 a[120:123], v14 offset:8192
    ds_read_b128 a[124:127], v14 offset:12288
    v_mfma_f32_32x32x16_bf16 v[112:127], a[140:143], a[84:87], v[112:127]
    s_waitcnt lgkmcnt(2)
    v_mfma_f32_32x32x16_bf16 v[64:79], a[112:115], a[88:91], v[64:79]
    ds_read_b128 a[92:95], v23 offset:0
    ds_read_b128 a[128:131], v15 offset:0
    ds_read_b128 a[132:135], v15 offset:4096
    buffer_load_dwordx4 v11, s[20:23], s75 offen offset:3072 lds
    v_mfma_f32_32x32x16_bf16 v[80:95], a[116:119], a[88:91], v[80:95]
    s_waitcnt lgkmcnt(3)
    v_mfma_f32_32x32x16_bf16 v[96:111], a[120:123], a[88:91], v[96:111]
    ds_read_b128 a[136:139], v15 offset:8192
    ds_read_b128 a[140:143], v15 offset:12288
    v_mfma_f32_32x32x16_bf16 v[112:127], a[124:127], a[88:91], v[112:127]
    s_waitcnt vmcnt(4)
    s_barrier
    s_waitcnt lgkmcnt(2)
    v_mfma_f32_32x32x16_bf16 v[64:79], a[128:131], a[92:95], v[64:79]
    ds_read_b128 a[96:99], v20 offset:16384
    ds_read_b128 a[112:115], v12 offset:16384
    ds_read_b128 a[116:119], v12 offset:20480
    s_add_u32 m0, s11, 49152
    s_add_u32 s75, s93, s57
    buffer_load_dwordx4 v8, s[20:23], s75 offen lds
    v_mfma_f32_32x32x16_bf16 v[80:95], a[132:135], a[92:95], v[80:95]
    s_waitcnt lgkmcnt(3)
    v_mfma_f32_32x32x16_bf16 v[96:111], a[136:139], a[92:95], v[96:111]
    ds_read_b128 a[120:123], v12 offset:24576
    ds_read_b128 a[124:127], v12 offset:28672
    v_mfma_f32_32x32x16_bf16 v[112:127], a[140:143], a[92:95], v[112:127]
    s_waitcnt lgkmcnt(2)
    v_mfma_f32_32x32x16_bf16 v[64:79], a[112:115], a[96:99], v[64:79]
    ds_read_b128 a[100:103], v21 offset:16384
    ds_read_b128 a[128:131], v13 offset:16384
    ds_read_b128 a[132:135], v13 offset:20480
    buffer_load_dwordx4 v9, s[20:23], s75 offen offset:1024 lds
    v_mfma_f32_32x32x16_bf16 v[80:95], a[116:119], a[96:99], v[80:95]
    s_waitcnt lgkmcnt(3)
    v_mfma_f32_32x32x16_bf16 v[96:111], a[120:123], a[96:99], v[96:111]
    ds_read_b128 a[136:139], v13 offset:24576
    ds_read_b128 a[140:143], v13 offset:28672
    v_mfma_f32_32x32x16_bf16 v[112:127], a[124:127], a[96:99], v[112:127]
    s_waitcnt lgkmcnt(2)
    v_mfma_f32_32x32x16_bf16 v[64:79], a[128:131], a[100:103], v[64:79]
    ds_read_b128 a[104:107], v22 offset:16384
    ds_read_b128 a[112:115], v14 offset:16384
    ds_read_b128 a[116:119], v14 offset:20480
    buffer_load_dwordx4 v10, s[20:23], s75 offen offset:2048 lds
    v_mfma_f32_32x32x16_bf16 v[80:95], a[132:135], a[100:103], v[80:95]
    s_waitcnt lgkmcnt(3)
    v_mfma_f32_32x32x16_bf16 v[96:111], a[136:139], a[100:103], v[96:111]
    ds_read_b128 a[120:123], v14 offset:24576
    ds_read_b128 a[124:127], v14 offset:28672
    v_mfma_f32_32x32x16_bf16 v[112:127], a[140:143], a[100:103], v[112:127]
    s_waitcnt lgkmcnt(2)
    v_mfma_f32_32x32x16_bf16 v[64:79], a[112:115], a[104:107], v[64:79]
    ds_read_b128 a[108:111], v23 offset:16384
    ds_read_b128 a[128:131], v15 offset:16384
    ds_read_b128 a[132:135], v15 offset:20480
    buffer_load_dwordx4 v11, s[20:23], s75 offen offset:3072 lds
    v_mfma_f32_32x32x16_bf16 v[80:95], a[116:119], a[104:107], v[80:95]
    s_waitcnt lgkmcnt(3)
    v_mfma_f32_32x32x16_bf16 v[96:111], a[120:123], a[104:107], v[96:111]
    ds_read_b128 a[136:139], v15 offset:24576
    ds_read_b128 a[140:143], v15 offset:28672
    v_mfma_f32_32x32x16_bf16 v[112:127], a[124:127], a[104:107], v[112:127]
    s_waitcnt vmcnt(4)
    s_barrier
    s_waitcnt lgkmcnt(2)
    v_mfma_f32_32x32x16_bf16 v[64:79], a[128:131], a[108:111], v[64:79]
    ds_read_b128 a[112:115], v12 offset:32768
    ds_read_b128 a[116:119], v12 offset:36864
    s_add_u32 m0, s11, 65536
    s_add_u32 s75, s94, s57
    buffer_load_dwordx4 v8, s[20:23], s75 offen lds
    v_mfma_f32_32x32x16_bf16 v[80:95], a[132:135], a[108:111], v[80:95]
    s_waitcnt lgkmcnt(2)
    v_mfma_f32_32x32x16_bf16 v[96:111], a[136:139], a[108:111], v[96:111]
    ds_read_b128 a[120:123], v12 offset:40960
    ds_read_b128 a[124:127], v12 offset:45056
    v_mfma_f32_32x32x16_bf16 v[112:127], a[140:143], a[108:111], v[112:127]
    s_nop 11
    s_cmp_lg_u32 s54, 1
    s_cbranch_scc1 L_nogate_14
    s_mov_b64 s[60:61], exec
    s_mov_b32 exec_lo, 1
    s_mov_b32 exec_hi, 1
    buffer_store_dwordx4 v[64:67], v29, s[36:39], s53 offen offset:0 sc1
    buffer_store_dwordx4 v[68:71], v29, s[36:39], s53 offen offset:32 sc1
    buffer_store_dwordx4 v[72:75], v29, s[36:39], s53 offen offset:64 sc1
    buffer_store_dwordx4 v[76:79], v29, s[36:39], s53 offen offset:96 sc1
    buffer_store_dwordx4 v[80:83], v29, s[36:39], s53 offen offset:128 sc1
    buffer_store_dwordx4 v[84:87], v29, s[36:39], s53 offen offset:160 sc1
    buffer_store_dwordx4 v[88:91], v29, s[36:39], s53 offen offset:192 sc1
    buffer_store_dwordx4 v[92:95], v29, s[36:39], s53 offen offset:224 sc1
    buffer_store_dwordx4 v[96:99], v29, s[36:39], s53 offen offset:256 sc1
    buffer_store_dwordx4 v[100:103], v29, s[36:39], s53 offen offset:288 sc1
    buffer_store_dwordx4 v[104:107], v29, s[36:39], s53 offen offset:320 sc1
    buffer_store_dwordx4 v[108:111], v29, s[36:39], s53 offen offset:352 sc1
    buffer_store_dwordx4 v[112:115], v29, s[36:39], s53 offen offset:384 sc1
    buffer_store_dwordx4 v[116:119], v29, s[36:39], s53 offen offset:416 sc1
    buffer_store_dwordx4 v[120:123], v29, s[36:39], s53 offen offset:448 sc1
    buffer_store_dwordx4 v[124:127], v29, s[36:39], s53 offen offset:480 sc1
    s_mov_b64 exec, s[60:61]
    s_nop 1
L_nogate_14:
    v_cvt_pk_bf16_f32 v192, v64, v65
    v_cvt_pk_bf16_f32 v193, v66, v67
    v_cvt_pk_bf16_f32 v194, v68, v69
    v_cvt_pk_bf16_f32 v195, v70, v71
    v_cvt_pk_bf16_f32 v196, v72, v73
    v_cvt_pk_bf16_f32 v197, v74, v75
    v_cvt_pk_bf16_f32 v198, v76, v77
    v_cvt_pk_bf16_f32 v199, v78, v79
    v_cvt_pk_bf16_f32 v200, v80, v81
    v_cvt_pk_bf16_f32 v201, v82, v83
    v_cvt_pk_bf16_f32 v202, v84, v85
    v_cvt_pk_bf16_f32 v203, v86, v87
    v_cvt_pk_bf16_f32 v204, v88, v89
    v_cvt_pk_bf16_f32 v205, v90, v91
    v_cvt_pk_bf16_f32 v206, v92, v93
    v_cvt_pk_bf16_f32 v207, v94, v95
    v_cvt_pk_bf16_f32 v208, v96, v97
    v_cvt_pk_bf16_f32 v209, v98, v99
    v_cvt_pk_bf16_f32 v210, v100, v101
    v_cvt_pk_bf16_f32 v211, v102, v103
    v_cvt_pk_bf16_f32 v212, v104, v105
    v_cvt_pk_bf16_f32 v213, v106, v107
    v_cvt_pk_bf16_f32 v214, v108, v109
    v_cvt_pk_bf16_f32 v215, v110, v111
    v_cvt_pk_bf16_f32 v216, v112, v113
    v_cvt_pk_bf16_f32 v217, v114, v115
    v_cvt_pk_bf16_f32 v218, v116, v117
    v_cvt_pk_bf16_f32 v219, v118, v119
    v_cvt_pk_bf16_f32 v220, v120, v121
    v_cvt_pk_bf16_f32 v221, v122, v123
    v_cvt_pk_bf16_f32 v222, v124, v125
    v_cvt_pk_bf16_f32 v223, v126, v127
    s_nop 1
    v_mfma_f32_32x32x16_bf16 v[96:111], v[192:195], a[144:147], 0
    v_mfma_f32_32x32x16_bf16 v[96:111], v[196:199], a[148:151], v[96:111]
    v_mfma_f32_32x32x16_bf16 v[112:127], v[192:195], a[152:155], 0
    v_mfma_f32_32x32x16_bf16 v[112:127], v[196:199], a[156:159], v[112:127]
    v_mfma_f32_32x32x16_bf16 v[128:143], v[200:203], a[144:147], 0
    v_mfma_f32_32x32x16_bf16 v[128:143], v[204:207], a[148:151], v[128:143]
    v_mfma_f32_32x32x16_bf16 v[144:159], v[200:203], a[152:155], 0
    v_mfma_f32_32x32x16_bf16 v[144:159], v[204:207], a[156:159], v[144:159]
    s_nop 11
    v_sub_f32 v96, v96, v120
    v_add_f32 v104, v112, v104
    v_sub_f32 v97, v97, v121
    v_add_f32 v105, v113, v105
    v_sub_f32 v98, v98, v122
    v_add_f32 v106, v114, v106
    v_sub_f32 v99, v99, v123
    v_add_f32 v107, v115, v107
    v_sub_f32 v100, v100, v124
    v_add_f32 v108, v116, v108
    v_sub_f32 v101, v101, v125
    v_add_f32 v109, v117, v109
    v_sub_f32 v102, v102, v126
    v_add_f32 v110, v118, v110
    v_sub_f32 v103, v103, v127
    v_add_f32 v111, v119, v111
    v_sub_f32 v128, v128, v152
    v_add_f32 v136, v144, v136
    v_sub_f32 v129, v129, v153
    v_add_f32 v137, v145, v137
    v_sub_f32 v130, v130, v154
    v_add_f32 v138, v146, v138
    v_sub_f32 v131, v131, v155
    v_add_f32 v139, v147, v139
    v_sub_f32 v132, v132, v156
    v_add_f32 v140, v148, v140
    v_sub_f32 v133, v133, v157
    v_add_f32 v141, v149, v141
    v_sub_f32 v134, v134, v158
    v_add_f32 v142, v150, v142
    v_sub_f32 v135, v135, v159
    v_add_f32 v143, v151, v143
    v_cvt_pk_bf16_f32 v224, v96, v128
    v_cvt_pk_bf16_f32 v64, -v104, -v136
    v_cvt_pk_bf16_f32 v228, v97, v129
    v_cvt_pk_bf16_f32 v68, -v105, -v137
    v_cvt_pk_bf16_f32 v232, v98, v130
    v_cvt_pk_bf16_f32 v72, -v106, -v138
    v_cvt_pk_bf16_f32 v236, v99, v131
    v_cvt_pk_bf16_f32 v76, -v107, -v139
    v_cvt_pk_bf16_f32 v240, v100, v132
    v_cvt_pk_bf16_f32 v80, -v108, -v140
    v_cvt_pk_bf16_f32 v244, v101, v133
    v_cvt_pk_bf16_f32 v84, -v109, -v141
    v_cvt_pk_bf16_f32 v248, v102, v134
    v_cvt_pk_bf16_f32 v88, -v110, -v142
    v_cvt_pk_bf16_f32 v252, v103, v135
    v_cvt_pk_bf16_f32 v92, -v111, -v143
    s_nop 2
    v_mfma_f32_32x32x16_bf16 v[96:111], v[208:211], a[144:147], 0
    v_mfma_f32_32x32x16_bf16 v[96:111], v[212:215], a[148:151], v[96:111]
    v_mfma_f32_32x32x16_bf16 v[112:127], v[208:211], a[152:155], 0
    v_mfma_f32_32x32x16_bf16 v[112:127], v[212:215], a[156:159], v[112:127]
    v_mfma_f32_32x32x16_bf16 v[128:143], v[216:219], a[144:147], 0
    v_mfma_f32_32x32x16_bf16 v[128:143], v[220:223], a[148:151], v[128:143]
    v_mfma_f32_32x32x16_bf16 v[144:159], v[216:219], a[152:155], 0
    v_mfma_f32_32x32x16_bf16 v[144:159], v[220:223], a[156:159], v[144:159]
    s_nop 11
    v_sub_f32 v96, v96, v120
    v_add_f32 v104, v112, v104
    v_sub_f32 v97, v97, v121
    v_add_f32 v105, v113, v105
    v_sub_f32 v98, v98, v122
    v_add_f32 v106, v114, v106
    v_sub_f32 v99, v99, v123
    v_add_f32 v107, v115, v107
    v_sub_f32 v100, v100, v124
    v_add_f32 v108, v116, v108
    v_sub_f32 v101, v101, v125
    v_add_f32 v109, v117, v109
    v_sub_f32 v102, v102, v126
    v_add_f32 v110, v118, v110
    v_sub_f32 v103, v103, v127
    v_add_f32 v111, v119, v111
    v_sub_f32 v128, v128, v152
    v_add_f32 v136, v144, v136
    v_sub_f32 v129, v129, v153
    v_add_f32 v137, v145, v137
    v_sub_f32 v130, v130, v154
    v_add_f32 v138, v146, v138
    v_sub_f32 v131, v131, v155
    v_add_f32 v139, v147, v139
    v_sub_f32 v132, v132, v156
    v_add_f32 v140, v148, v140
    v_sub_f32 v133, v133, v157
    v_add_f32 v141, v149, v141
    v_sub_f32 v134, v134, v158
    v_add_f32 v142, v150, v142
    v_sub_f32 v135, v135, v159
    v_add_f32 v143, v151, v143
    v_cvt_pk_bf16_f32 v225, v96, v128
    v_cvt_pk_bf16_f32 v65, -v104, -v136
    v_cvt_pk_bf16_f32 v229, v97, v129
    v_cvt_pk_bf16_f32 v69, -v105, -v137
    v_cvt_pk_bf16_f32 v233, v98, v130
    v_cvt_pk_bf16_f32 v73, -v106, -v138
    v_cvt_pk_bf16_f32 v237, v99, v131
    v_cvt_pk_bf16_f32 v77, -v107, -v139
    v_cvt_pk_bf16_f32 v241, v100, v132
    v_cvt_pk_bf16_f32 v81, -v108, -v140
    v_cvt_pk_bf16_f32 v245, v101, v133
    v_cvt_pk_bf16_f32 v85, -v109, -v141
    v_cvt_pk_bf16_f32 v249, v102, v134
    v_cvt_pk_bf16_f32 v89, -v110, -v142
    v_cvt_pk_bf16_f32 v253, v103, v135
    v_cvt_pk_bf16_f32 v93, -v111, -v143
    s_nop 2
    s_waitcnt lgkmcnt(2)
    v_mfma_f32_32x32x16_bf16 v[128:143], a[112:115], a[0:3], 0
    ds_read_b128 a[128:131], v13 offset:32768
    ds_read_b128 a[132:135], v13 offset:36864
    buffer_load_dwordx4 v9, s[20:23], s75 offen offset:1024 lds
    v_mfma_f32_32x32x16_bf16 v[144:159], a[116:119], a[0:3], 0
    s_waitcnt lgkmcnt(2)
    v_mfma_f32_32x32x16_bf16 v[160:175], a[120:123], a[0:3], 0
    ds_read_b128 a[136:139], v13 offset:40960
    ds_read_b128 a[140:143], v13 offset:45056
    v_mfma_f32_32x32x16_bf16 v[176:191], a[124:127], a[0:3], 0
    s_waitcnt lgkmcnt(2)
    v_mfma_f32_32x32x16_bf16 v[128:143], a[128:131], a[4:7], v[128:143]
    ds_read_b128 a[112:115], v14 offset:32768
    ds_read_b128 a[116:119], v14 offset:36864
    buffer_load_dwordx4 v10, s[20:23], s75 offen offset:2048 lds
    v_mfma_f32_32x32x16_bf16 v[144:159], a[132:135], a[4:7], v[144:159]
    s_waitcnt lgkmcnt(2)
    v_mfma_f32_32x32x16_bf16 v[160:175], a[136:139], a[4:7], v[160:175]
    ds_read_b128 a[120:123], v14 offset:40960
    ds_read_b128 a[124:127], v14 offset:45056
    v_mfma_f32_32x32x16_bf16 v[176:191], a[140:143], a[4:7], v[176:191]
    s_waitcnt lgkmcnt(2)
    v_mfma_f32_32x32x16_bf16 v[128:143], a[112:115], a[8:11], v[128:143]
    ds_read_b128 a[128:131], v15 offset:32768
    ds_read_b128 a[132:135], v15 offset:36864
    buffer_load_dwordx4 v11, s[20:23], s75 offen offset:3072 lds
    v_mfma_f32_32x32x16_bf16 v[144:159], a[116:119], a[8:11], v[144:159]
    s_waitcnt lgkmcnt(2)
    v_mfma_f32_32x32x16_bf16 v[160:175], a[120:123], a[8:11], v[160:175]
    ds_read_b128 a[136:139], v15 offset:40960
    ds_read_b128 a[140:143], v15 offset:45056
    v_mfma_f32_32x32x16_bf16 v[176:191], a[124:127], a[8:11], v[176:191]
    s_waitcnt vmcnt(4)
    s_barrier
    s_waitcnt lgkmcnt(2)
    v_mfma_f32_32x32x16_bf16 v[128:143], a[128:131], a[12:15], v[128:143]
    ds_read_b128 a[112:115], v12 offset:49152
    ds_read_b128 a[116:119], v12 offset:53248
    s_add_u32 m0, s11, 0
    s_add_u32 s75, s95, s57
    buffer_load_dwordx4 v8, s[20:23], s75 offen lds
    v_mfma_f32_32x32x16_bf16 v[144:159], a[132:135], a[12:15], v[144:159]
    s_waitcnt lgkmcnt(2)
    v_mfma_f32_32x32x16_bf16 v[160:175], a[136:139], a[12:15], v[160:175]
    ds_read_b128 a[120:123], v12 offset:57344
    ds_read_b128 a[124:127], v12 offset:61440
    v_mfma_f32_32x32x16_bf16 v[176:191], a[140:143], a[12:15], v[176:191]
    s_waitcnt lgkmcnt(2)
    v_mfma_f32_32x32x16_bf16 v[128:143], a[112:115], a[16:19], v[128:143]
    ds_read_b128 a[128:131], v13 offset:49152
    ds_read_b128 a[132:135], v13 offset:53248
    buffer_load_dwordx4 v9, s[20:23], s75 offen offset:1024 lds
    v_mfma_f32_32x32x16_bf16 v[144:159], a[116:119], a[16:19], v[144:159]
    s_waitcnt lgkmcnt(2)
    v_mfma_f32_32x32x16_bf16 v[160:175], a[120:123], a[16:19], v[160:175]
    ds_read_b128 a[136:139], v13 offset:57344
    ds_read_b128 a[140:143], v13 offset:61440
    v_mfma_f32_32x32x16_bf16 v[176:191], a[124:127], a[16:19], v[176:191]
    s_waitcnt lgkmcnt(2)
    v_mfma_f32_32x32x16_bf16 v[128:143], a[128:131], a[20:23], v[128:143]
    ds_read_b128 a[112:115], v14 offset:49152
    ds_read_b128 a[116:119], v14 offset:53248
    buffer_load_dwordx4 v10, s[20:23], s75 offen offset:2048 lds
    v_mfma_f32_32x32x16_bf16 v[144:159], a[132:135], a[20:23], v[144:159]
    s_waitcnt lgkmcnt(2)
    v_mfma_f32_32x32x16_bf16 v[160:175], a[136:139], a[20:23], v[160:175]
    ds_read_b128 a[120:123], v14 offset:57344
    ds_read_b128 a[124:127], v14 offset:61440
    v_mfma_f32_32x32x16_bf16 v[176:191], a[140:143], a[20:23], v[176:191]
    s_waitcnt lgkmcnt(2)
    v_mfma_f32_32x32x16_bf16 v[128:143], a[112:115], a[24:27], v[128:143]
    ds_read_b128 a[128:131], v15 offset:49152
    ds_read_b128 a[132:135], v15 offset:53248
    buffer_load_dwordx4 v11, s[20:23], s75 offen offset:3072 lds
    v_mfma_f32_32x32x16_bf16 v[144:159], a[116:119], a[24:27], v[144:159]
    s_waitcnt lgkmcnt(2)
    v_mfma_f32_32x32x16_bf16 v[160:175], a[120:123], a[24:27], v[160:175]
    ds_read_b128 a[136:139], v15 offset:57344
    ds_read_b128 a[140:143], v15 offset:61440
    v_mfma_f32_32x32x16_bf16 v[176:191], a[124:127], a[24:27], v[176:191]
    s_waitcnt vmcnt(4)
    s_barrier
    s_waitcnt lgkmcnt(2)
    v_mfma_f32_32x32x16_bf16 v[128:143], a[128:131], a[28:31], v[128:143]
    ds_read_b128 a[112:115], v30 offset:0
    ds_read_b128 a[116:119], v30 offset:4096
    s_add_u32 m0, s11, 16384
    s_add_u32 s75, s96, s57
    buffer_load_dwordx4 v8, s[20:23], s75 offen lds
    v_mfma_f32_32x32x16_bf16 v[144:159], a[132:135], a[28:31], v[144:159]
    s_waitcnt lgkmcnt(2)
    v_mfma_f32_32x32x16_bf16 v[160:175], a[136:139], a[28:31], v[160:175]
    ds_read_b128 a[120:123], v30 offset:8192
    ds_read_b128 a[124:127], v30 offset:12288
    v_mfma_f32_32x32x16_bf16 v[176:191], a[140:143], a[28:31], v[176:191]
    s_waitcnt lgkmcnt(2)
    v_mfma_f32_32x32x16_bf16 v[128:143], a[112:115], a[32:35], v[128:143]
    ds_read_b128 a[128:131], v31 offset:0
    ds_read_b128 a[132:135], v31 offset:4096
    buffer_load_dwordx4 v9, s[20:23], s75 offen offset:1024 lds
    v_mfma_f32_32x32x16_bf16 v[144:159], a[116:119], a[32:35], v[144:159]
    s_waitcnt lgkmcnt(2)
    v_mfma_f32_32x32x16_bf16 v[160:175], a[120:123], a[32:35], v[160:175]
    ds_read_b128 a[136:139], v31 offset:8192
    ds_read_b128 a[140:143], v31 offset:12288
    v_mfma_f32_32x32x16_bf16 v[176:191], a[124:127], a[32:35], v[176:191]
    s_waitcnt lgkmcnt(2)
    v_mfma_f32_32x32x16_bf16 v[128:143], a[128:131], a[36:39], v[128:143]
    ds_read_b128 a[112:115], v32 offset:0
    ds_read_b128 a[116:119], v32 offset:4096
    buffer_load_dwordx4 v10, s[20:23], s75 offen offset:2048 lds
    v_mfma_f32_32x32x16_bf16 v[144:159], a[132:135], a[36:39], v[144:159]
    s_waitcnt lgkmcnt(2)
    v_mfma_f32_32x32x16_bf16 v[160:175], a[136:139], a[36:39], v[160:175]
    ds_read_b128 a[120:123], v32 offset:8192
    ds_read_b128 a[124:127], v32 offset:12288
    v_mfma_f32_32x32x16_bf16 v[176:191], a[140:143], a[36:39], v[176:191]
    s_waitcnt lgkmcnt(2)
    v_mfma_f32_32x32x16_bf16 v[128:143], a[112:115], a[40:43], v[128:143]
    ds_read_b128 a[128:131], v33 offset:0
    ds_read_b128 a[132:135], v33 offset:4096
    buffer_load_dwordx4 v11, s[20:23], s75 offen offset:3072 lds
    v_mfma_f32_32x32x16_bf16 v[144:159], a[116:119], a[40:43], v[144:159]
    s_waitcnt lgkmcnt(2)
    v_mfma_f32_32x32x16_bf16 v[160:175], a[120:123], a[40:43], v[160:175]
    ds_read_b128 a[136:139], v33 offset:8192
    ds_read_b128 a[140:143], v33 offset:12288
    v_mfma_f32_32x32x16_bf16 v[176:191], a[124:127], a[40:43], v[176:191]
    s_waitcnt vmcnt(4)
    s_barrier
    s_waitcnt lgkmcnt(2)
    v_mfma_f32_32x32x16_bf16 v[128:143], a[128:131], a[44:47], v[128:143]
    ds_read_b128 a[112:115], v12 offset:0
    ds_read_b128 a[116:119], v12 offset:4096
    s_add_u32 m0, s11, 32768
    s_add_u32 s75, s97, s57
    buffer_load_dwordx4 v8, s[20:23], s75 offen lds
    v_mfma_f32_32x32x16_bf16 v[144:159], a[132:135], a[44:47], v[144:159]
    s_waitcnt lgkmcnt(2)
    v_mfma_f32_32x32x16_bf16 v[160:175], a[136:139], a[44:47], v[160:175]
    ds_read_b128 a[120:123], v12 offset:8192
    ds_read_b128 a[124:127], v12 offset:12288
    v_mfma_f32_32x32x16_bf16 v[176:191], a[140:143], a[44:47], v[176:191]
    s_waitcnt lgkmcnt(2)
    v_mfma_f32_32x32x16_bf16 v[128:143], a[112:115], a[48:51], v[128:143]
    ds_read_b128 a[128:131], v13 offset:0
    ds_read_b128 a[132:135], v13 offset:4096
    buffer_load_dwordx4 v9, s[20:23], s75 offen offset:1024 lds
    v_mfma_f32_32x32x16_bf16 v[144:159], a[116:119], a[48:51], v[144:159]
    s_waitcnt lgkmcnt(2)
    v_mfma_f32_32x32x16_bf16 v[160:175], a[120:123], a[48:51], v[160:175]
    ds_read_b128 a[136:139], v13 offset:8192
    ds_read_b128 a[140:143], v13 offset:12288
    v_mfma_f32_32x32x16_bf16 v[176:191], a[124:127], a[48:51], v[176:191]
    s_waitcnt lgkmcnt(2)
    v_mfma_f32_32x32x16_bf16 v[128:143], a[128:131], a[52:55], v[128:143]
    ds_read_b128 a[112:115], v14 offset:0
    ds_read_b128 a[116:119], v14 offset:4096
    buffer_load_dwordx4 v10, s[20:23], s75 offen offset:2048 lds
    v_mfma_f32_32x32x16_bf16 v[144:159], a[132:135], a[52:55], v[144:159]
    s_waitcnt lgkmcnt(2)
    v_mfma_f32_32x32x16_bf16 v[160:175], a[136:139], a[52:55], v[160:175]
    ds_read_b128 a[120:123], v14 offset:8192
    ds_read_b128 a[124:127], v14 offset:12288
    v_mfma_f32_32x32x16_bf16 v[176:191], a[140:143], a[52:55], v[176:191]
    s_waitcnt lgkmcnt(2)
    v_mfma_f32_32x32x16_bf16 v[128:143], a[112:115], a[56:59], v[128:143]
    ds_read_b128 a[128:131], v15 offset:0
    ds_read_b128 a[132:135], v15 offset:4096
    buffer_load_dwordx4 v11, s[20:23], s75 offen offset:3072 lds
    v_mfma_f32_32x32x16_bf16 v[144:159], a[116:119], a[56:59], v[144:159]
    s_waitcnt lgkmcnt(2)
    v_mfma_f32_32x32x16_bf16 v[160:175], a[120:123], a[56:59], v[160:175]
    ds_read_b128 a[136:139], v15 offset:8192
    ds_read_b128 a[140:143], v15 offset:12288
    v_mfma_f32_32x32x16_bf16 v[176:191], a[124:127], a[56:59], v[176:191]
    s_waitcnt vmcnt(4)
    s_barrier
    s_waitcnt lgkmcnt(2)
    v_mfma_f32_32x32x16_bf16 v[128:143], a[128:131], a[60:63], v[128:143]
    ds_read_b128 a[112:115], v12 offset:16384
    ds_read_b128 a[116:119], v12 offset:20480
    s_add_u32 m0, s11, 49152
    s_add_u32 s75, s98, s57
    buffer_load_dwordx4 v8, s[20:23], s75 offen lds
    v_mfma_f32_32x32x16_bf16 v[144:159], a[132:135], a[60:63], v[144:159]
    s_waitcnt lgkmcnt(2)
    v_mfma_f32_32x32x16_bf16 v[160:175], a[136:139], a[60:63], v[160:175]
    ds_read_b128 a[120:123], v12 offset:24576
    ds_read_b128 a[124:127], v12 offset:28672
    v_mfma_f32_32x32x16_bf16 v[176:191], a[140:143], a[60:63], v[176:191]
    s_waitcnt lgkmcnt(2)
    v_mfma_f32_32x32x16_bf16 v[128:143], a[112:115], a[64:67], v[128:143]
    ds_read_b128 a[128:131], v13 offset:16384
    ds_read_b128 a[132:135], v13 offset:20480
    buffer_load_dwordx4 v9, s[20:23], s75 offen offset:1024 lds
    v_mfma_f32_32x32x16_bf16 v[144:159], a[116:119], a[64:67], v[144:159]
    s_waitcnt lgkmcnt(2)
    v_mfma_f32_32x32x16_bf16 v[160:175], a[120:123], a[64:67], v[160:175]
    ds_read_b128 a[136:139], v13 offset:24576
    ds_read_b128 a[140:143], v13 offset:28672
    v_mfma_f32_32x32x16_bf16 v[176:191], a[124:127], a[64:67], v[176:191]
    s_waitcnt lgkmcnt(2)
    v_mfma_f32_32x32x16_bf16 v[128:143], a[128:131], a[68:71], v[128:143]
    ds_read_b128 a[112:115], v14 offset:16384
    ds_read_b128 a[116:119], v14 offset:20480
    buffer_load_dwordx4 v10, s[20:23], s75 offen offset:2048 lds
    v_mfma_f32_32x32x16_bf16 v[144:159], a[132:135], a[68:71], v[144:159]
    s_waitcnt lgkmcnt(2)
    v_mfma_f32_32x32x16_bf16 v[160:175], a[136:139], a[68:71], v[160:175]
    ds_read_b128 a[120:123], v14 offset:24576
    ds_read_b128 a[124:127], v14 offset:28672
    v_mfma_f32_32x32x16_bf16 v[176:191], a[140:143], a[68:71], v[176:191]
    s_waitcnt lgkmcnt(2)
    v_mfma_f32_32x32x16_bf16 v[128:143], a[112:115], a[72:75], v[128:143]
    ds_read_b128 a[128:131], v15 offset:16384
    ds_read_b128 a[132:135], v15 offset:20480
    buffer_load_dwordx4 v11, s[20:23], s75 offen offset:3072 lds
    v_mfma_f32_32x32x16_bf16 v[144:159], a[116:119], a[72:75], v[144:159]
    s_waitcnt lgkmcnt(2)
    v_mfma_f32_32x32x16_bf16 v[160:175], a[120:123], a[72:75], v[160:175]
    ds_read_b128 a[136:139], v15 offset:24576
    ds_read_b128 a[140:143], v15 offset:28672
    v_mfma_f32_32x32x16_bf16 v[176:191], a[124:127], a[72:75], v[176:191]
    s_waitcnt vmcnt(4)
    s_barrier
    s_waitcnt lgkmcnt(2)
    v_mfma_f32_32x32x16_bf16 v[128:143], a[128:131], a[76:79], v[128:143]
    ds_read_b128 a[112:115], v12 offset:32768
    ds_read_b128 a[116:119], v12 offset:36864
    v_mfma_f32_32x32x16_bf16 v[144:159], a[132:135], a[76:79], v[144:159]
    s_waitcnt lgkmcnt(2)
    v_mfma_f32_32x32x16_bf16 v[160:175], a[136:139], a[76:79], v[160:175]
    ds_read_b128 a[120:123], v12 offset:40960
    ds_read_b128 a[124:127], v12 offset:45056
    v_mfma_f32_32x32x16_bf16 v[176:191], a[140:143], a[76:79], v[176:191]
    s_waitcnt lgkmcnt(2)
    v_mfma_f32_32x32x16_bf16 v[128:143], a[112:115], a[80:83], v[128:143]
    ds_read_b128 a[128:131], v13 offset:32768
    ds_read_b128 a[132:135], v13 offset:36864
    v_mfma_f32_32x32x16_bf16 v[144:159], a[116:119], a[80:83], v[144:159]
    s_waitcnt lgkmcnt(2)
    v_mfma_f32_32x32x16_bf16 v[160:175], a[120:123], a[80:83], v[160:175]
    ds_read_b128 a[136:139], v13 offset:40960
    ds_read_b128 a[140:143], v13 offset:45056
    v_mfma_f32_32x32x16_bf16 v[176:191], a[124:127], a[80:83], v[176:191]
    s_waitcnt lgkmcnt(2)
    v_mfma_f32_32x32x16_bf16 v[128:143], a[128:131], a[84:87], v[128:143]
    ds_read_b128 a[112:115], v14 offset:32768
    ds_read_b128 a[116:119], v14 offset:36864
    v_mfma_f32_32x32x16_bf16 v[144:159], a[132:135], a[84:87], v[144:159]
    s_waitcnt lgkmcnt(2)
    v_mfma_f32_32x32x16_bf16 v[160:175], a[136:139], a[84:87], v[160:175]
    ds_read_b128 a[120:123], v14 offset:40960
    ds_read_b128 a[124:127], v14 offset:45056
    v_mfma_f32_32x32x16_bf16 v[176:191], a[140:143], a[84:87], v[176:191]
    s_waitcnt lgkmcnt(2)
    v_mfma_f32_32x32x16_bf16 v[128:143], a[112:115], a[88:91], v[128:143]
    ds_read_b128 a[128:131], v15 offset:32768
    ds_read_b128 a[132:135], v15 offset:36864
    v_mfma_f32_32x32x16_bf16 v[144:159], a[116:119], a[88:91], v[144:159]
    s_waitcnt lgkmcnt(2)
    v_mfma_f32_32x32x16_bf16 v[160:175], a[120:123], a[88:91], v[160:175]
    ds_read_b128 a[136:139], v15 offset:40960
    ds_read_b128 a[140:143], v15 offset:45056
    v_mfma_f32_32x32x16_bf16 v[176:191], a[124:127], a[88:91], v[176:191]
    s_waitcnt vmcnt(0)
    s_barrier
    s_waitcnt lgkmcnt(2)
    v_mfma_f32_32x32x16_bf16 v[128:143], a[128:131], a[92:95], v[128:143]
    ds_read_b128 a[112:115], v12 offset:49152
    ds_read_b128 a[116:119], v12 offset:53248
    v_mfma_f32_32x32x16_bf16 v[144:159], a[132:135], a[92:95], v[144:159]
    s_waitcnt lgkmcnt(2)
    v_mfma_f32_32x32x16_bf16 v[160:175], a[136:139], a[92:95], v[160:175]
    ds_read_b128 a[120:123], v12 offset:57344
    ds_read_b128 a[124:127], v12 offset:61440
    v_mfma_f32_32x32x16_bf16 v[176:191], a[140:143], a[92:95], v[176:191]
    s_waitcnt lgkmcnt(2)
    v_mfma_f32_32x32x16_bf16 v[128:143], a[112:115], a[96:99], v[128:143]
    ds_read_b128 a[128:131], v13 offset:49152
    ds_read_b128 a[132:135], v13 offset:53248
    v_mfma_f32_32x32x16_bf16 v[144:159], a[116:119], a[96:99], v[144:159]
    s_waitcnt lgkmcnt(2)
    v_mfma_f32_32x32x16_bf16 v[160:175], a[120:123], a[96:99], v[160:175]
    ds_read_b128 a[136:139], v13 offset:57344
    ds_read_b128 a[140:143], v13 offset:61440
    v_mfma_f32_32x32x16_bf16 v[176:191], a[124:127], a[96:99], v[176:191]
    s_waitcnt lgkmcnt(2)
    v_mfma_f32_32x32x16_bf16 v[128:143], a[128:131], a[100:103], v[128:143]
    ds_read_b128 a[112:115], v14 offset:49152
    ds_read_b128 a[116:119], v14 offset:53248
    v_mfma_f32_32x32x16_bf16 v[144:159], a[132:135], a[100:103], v[144:159]
    s_waitcnt lgkmcnt(2)
    v_mfma_f32_32x32x16_bf16 v[160:175], a[136:139], a[100:103], v[160:175]
    ds_read_b128 a[120:123], v14 offset:57344
    ds_read_b128 a[124:127], v14 offset:61440
    v_mfma_f32_32x32x16_bf16 v[176:191], a[140:143], a[100:103], v[176:191]
    s_waitcnt lgkmcnt(2)
    v_mfma_f32_32x32x16_bf16 v[128:143], a[112:115], a[104:107], v[128:143]
    ds_read_b128 a[128:131], v15 offset:49152
    ds_read_b128 a[132:135], v15 offset:53248
    v_mfma_f32_32x32x16_bf16 v[144:159], a[116:119], a[104:107], v[144:159]
    s_waitcnt lgkmcnt(2)
    v_mfma_f32_32x32x16_bf16 v[160:175], a[120:123], a[104:107], v[160:175]
    ds_read_b128 a[136:139], v15 offset:57344
    ds_read_b128 a[140:143], v15 offset:61440
    v_mfma_f32_32x32x16_bf16 v[176:191], a[124:127], a[104:107], v[176:191]
    s_waitcnt lgkmcnt(2)
    v_mfma_f32_32x32x16_bf16 v[128:143], a[128:131], a[108:111], v[128:143]
    v_mfma_f32_32x32x16_bf16 v[144:159], a[132:135], a[108:111], v[144:159]
    s_waitcnt lgkmcnt(0)
    v_mfma_f32_32x32x16_bf16 v[160:175], a[136:139], a[108:111], v[160:175]
    v_mfma_f32_32x32x16_bf16 v[176:191], a[140:143], a[108:111], v[176:191]
    s_nop 11
    s_cmp_lg_u32 s54, 1
    s_cbranch_scc1 L_nogate_15
    s_mov_b64 s[60:61], exec
    s_mov_b32 exec_lo, 1
    s_mov_b32 exec_hi, 1
    buffer_store_dwordx4 v[128:131], v29, s[36:39], s53 offen offset:512 sc1
    buffer_store_dwordx4 v[132:135], v29, s[36:39], s53 offen offset:544 sc1
    buffer_store_dwordx4 v[136:139], v29, s[36:39], s53 offen offset:576 sc1
    buffer_store_dwordx4 v[140:143], v29, s[36:39], s53 offen offset:608 sc1
    buffer_store_dwordx4 v[144:147], v29, s[36:39], s53 offen offset:640 sc1
    buffer_store_dwordx4 v[148:151], v29, s[36:39], s53 offen offset:672 sc1
    buffer_store_dwordx4 v[152:155], v29, s[36:39], s53 offen offset:704 sc1
    buffer_store_dwordx4 v[156:159], v29, s[36:39], s53 offen offset:736 sc1
    buffer_store_dwordx4 v[160:163], v29, s[36:39], s53 offen offset:768 sc1
    buffer_store_dwordx4 v[164:167], v29, s[36:39], s53 offen offset:800 sc1
    buffer_store_dwordx4 v[168:171], v29, s[36:39], s53 offen offset:832 sc1
    buffer_store_dwordx4 v[172:175], v29, s[36:39], s53 offen offset:864 sc1
    buffer_store_dwordx4 v[176:179], v29, s[36:39], s53 offen offset:896 sc1
    buffer_store_dwordx4 v[180:183], v29, s[36:39], s53 offen offset:928 sc1
    buffer_store_dwordx4 v[184:187], v29, s[36:39], s53 offen offset:960 sc1
    buffer_store_dwordx4 v[188:191], v29, s[36:39], s53 offen offset:992 sc1
    s_mov_b64 exec, s[60:61]
    s_nop 1
L_nogate_15:
    v_cvt_pk_bf16_f32 v192, v128, v129
    v_cvt_pk_bf16_f32 v193, v130, v131
    v_cvt_pk_bf16_f32 v194, v132, v133
    v_cvt_pk_bf16_f32 v195, v134, v135
    v_cvt_pk_bf16_f32 v196, v136, v137
    v_cvt_pk_bf16_f32 v197, v138, v139
    v_cvt_pk_bf16_f32 v198, v140, v141
    v_cvt_pk_bf16_f32 v199, v142, v143
    v_cvt_pk_bf16_f32 v200, v144, v145
    v_cvt_pk_bf16_f32 v201, v146, v147
    v_cvt_pk_bf16_f32 v202, v148, v149
    v_cvt_pk_bf16_f32 v203, v150, v151
    v_cvt_pk_bf16_f32 v204, v152, v153
    v_cvt_pk_bf16_f32 v205, v154, v155
    v_cvt_pk_bf16_f32 v206, v156, v157
    v_cvt_pk_bf16_f32 v207, v158, v159
    v_cvt_pk_bf16_f32 v208, v160, v161
    v_cvt_pk_bf16_f32 v209, v162, v163
    v_cvt_pk_bf16_f32 v210, v164, v165
    v_cvt_pk_bf16_f32 v211, v166, v167
    v_cvt_pk_bf16_f32 v212, v168, v169
    v_cvt_pk_bf16_f32 v213, v170, v171
    v_cvt_pk_bf16_f32 v214, v172, v173
    v_cvt_pk_bf16_f32 v215, v174, v175
    v_cvt_pk_bf16_f32 v216, v176, v177
    v_cvt_pk_bf16_f32 v217, v178, v179
    v_cvt_pk_bf16_f32 v218, v180, v181
    v_cvt_pk_bf16_f32 v219, v182, v183
    v_cvt_pk_bf16_f32 v220, v184, v185
    v_cvt_pk_bf16_f32 v221, v186, v187
    v_cvt_pk_bf16_f32 v222, v188, v189
    v_cvt_pk_bf16_f32 v223, v190, v191
    s_nop 1
    v_mfma_f32_32x32x16_bf16 v[96:111], v[192:195], a[144:147], 0
    v_mfma_f32_32x32x16_bf16 v[96:111], v[196:199], a[148:151], v[96:111]
    v_mfma_f32_32x32x16_bf16 v[112:127], v[192:195], a[152:155], 0
    v_mfma_f32_32x32x16_bf16 v[112:127], v[196:199], a[156:159], v[112:127]
    v_mfma_f32_32x32x16_bf16 v[128:143], v[200:203], a[144:147], 0
    v_mfma_f32_32x32x16_bf16 v[128:143], v[204:207], a[148:151], v[128:143]
    v_mfma_f32_32x32x16_bf16 v[144:159], v[200:203], a[152:155], 0
    v_mfma_f32_32x32x16_bf16 v[144:159], v[204:207], a[156:159], v[144:159]
    s_nop 11
    v_sub_f32 v96, v96, v120
    v_add_f32 v104, v112, v104
    v_sub_f32 v97, v97, v121
    v_add_f32 v105, v113, v105
    v_sub_f32 v98, v98, v122
    v_add_f32 v106, v114, v106
    v_sub_f32 v99, v99, v123
    v_add_f32 v107, v115, v107
    v_sub_f32 v100, v100, v124
    v_add_f32 v108, v116, v108
    v_sub_f32 v101, v101, v125
    v_add_f32 v109, v117, v109
    v_sub_f32 v102, v102, v126
    v_add_f32 v110, v118, v110
    v_sub_f32 v103, v103, v127
    v_add_f32 v111, v119, v111
    v_sub_f32 v128, v128, v152
    v_add_f32 v136, v144, v136
    v_sub_f32 v129, v129, v153
    v_add_f32 v137, v145, v137
    v_sub_f32 v130, v130, v154
    v_add_f32 v138, v146, v138
    v_sub_f32 v131, v131, v155
    v_add_f32 v139, v147, v139
    v_sub_f32 v132, v132, v156
    v_add_f32 v140, v148, v140
    v_sub_f32 v133, v133, v157
    v_add_f32 v141, v149, v141
    v_sub_f32 v134, v134, v158
    v_add_f32 v142, v150, v142
    v_sub_f32 v135, v135, v159
    v_add_f32 v143, v151, v143
    v_cvt_pk_bf16_f32 v226, v96, v128
    v_cvt_pk_bf16_f32 v66, -v104, -v136
    v_cvt_pk_bf16_f32 v230, v97, v129
    v_cvt_pk_bf16_f32 v70, -v105, -v137
    v_cvt_pk_bf16_f32 v234, v98, v130
    v_cvt_pk_bf16_f32 v74, -v106, -v138
    v_cvt_pk_bf16_f32 v238, v99, v131
    v_cvt_pk_bf16_f32 v78, -v107, -v139
    v_cvt_pk_bf16_f32 v242, v100, v132
    v_cvt_pk_bf16_f32 v82, -v108, -v140
    v_cvt_pk_bf16_f32 v246, v101, v133
    v_cvt_pk_bf16_f32 v86, -v109, -v141
    v_cvt_pk_bf16_f32 v250, v102, v134
    v_cvt_pk_bf16_f32 v90, -v110, -v142
    v_cvt_pk_bf16_f32 v254, v103, v135
    v_cvt_pk_bf16_f32 v94, -v111, -v143
    s_nop 2
    v_mfma_f32_32x32x16_bf16 v[96:111], v[208:211], a[144:147], 0
    v_mfma_f32_32x32x16_bf16 v[96:111], v[212:215], a[148:151], v[96:111]
    v_mfma_f32_32x32x16_bf16 v[112:127], v[208:211], a[152:155], 0
    v_mfma_f32_32x32x16_bf16 v[112:127], v[212:215], a[156:159], v[112:127]
    v_mfma_f32_32x32x16_bf16 v[128:143], v[216:219], a[144:147], 0
    v_mfma_f32_32x32x16_bf16 v[128:143], v[220:223], a[148:151], v[128:143]
    v_mfma_f32_32x32x16_bf16 v[144:159], v[216:219], a[152:155], 0
    v_mfma_f32_32x32x16_bf16 v[144:159], v[220:223], a[156:159], v[144:159]
    s_nop 11
    v_sub_f32 v96, v96, v120
    v_add_f32 v104, v112, v104
    v_sub_f32 v97, v97, v121
    v_add_f32 v105, v113, v105
    v_sub_f32 v98, v98, v122
    v_add_f32 v106, v114, v106
    v_sub_f32 v99, v99, v123
    v_add_f32 v107, v115, v107
    v_sub_f32 v100, v100, v124
    v_add_f32 v108, v116, v108
    v_sub_f32 v101, v101, v125
    v_add_f32 v109, v117, v109
    v_sub_f32 v102, v102, v126
    v_add_f32 v110, v118, v110
    v_sub_f32 v103, v103, v127
    v_add_f32 v111, v119, v111
    v_sub_f32 v128, v128, v152
    v_add_f32 v136, v144, v136
    v_sub_f32 v129, v129, v153
    v_add_f32 v137, v145, v137
    v_sub_f32 v130, v130, v154
    v_add_f32 v138, v146, v138
    v_sub_f32 v131, v131, v155
    v_add_f32 v139, v147, v139
    v_sub_f32 v132, v132, v156
    v_add_f32 v140, v148, v140
    v_sub_f32 v133, v133, v157
    v_add_f32 v141, v149, v141
    v_sub_f32 v134, v134, v158
    v_add_f32 v142, v150, v142
    v_sub_f32 v135, v135, v159
    v_add_f32 v143, v151, v143
    v_cvt_pk_bf16_f32 v227, v96, v128
    v_cvt_pk_bf16_f32 v67, -v104, -v136
    v_cvt_pk_bf16_f32 v231, v97, v129
    v_cvt_pk_bf16_f32 v71, -v105, -v137
    v_cvt_pk_bf16_f32 v235, v98, v130
    v_cvt_pk_bf16_f32 v75, -v106, -v138
    v_cvt_pk_bf16_f32 v239, v99, v131
    v_cvt_pk_bf16_f32 v79, -v107, -v139
    v_cvt_pk_bf16_f32 v243, v100, v132
    v_cvt_pk_bf16_f32 v83, -v108, -v140
    v_cvt_pk_bf16_f32 v247, v101, v133
    v_cvt_pk_bf16_f32 v87, -v109, -v141
    v_cvt_pk_bf16_f32 v251, v102, v134
    v_cvt_pk_bf16_f32 v91, -v110, -v142
    v_cvt_pk_bf16_f32 v255, v103, v135
    v_cvt_pk_bf16_f32 v95, -v111, -v143
    s_nop 2
    s_waitcnt lgkmcnt(0)
    s_barrier
    ds_write_b128 v28, v[224:227] offset:0
    ds_write_b128 v28, v[64:67] offset:16
    ds_write_b128 v28, v[228:231] offset:32
    ds_write_b128 v28, v[68:71] offset:48
    ds_write_b128 v28, v[232:235] offset:64
    ds_write_b128 v28, v[72:75] offset:80
    ds_write_b128 v28, v[236:239] offset:96
    ds_write_b128 v28, v[76:79] offset:112
    ds_write_b128 v28, v[240:243] offset:256
    ds_write_b128 v28, v[80:83] offset:272
    ds_write_b128 v28, v[244:247] offset:288
    ds_write_b128 v28, v[84:87] offset:304
    ds_write_b128 v28, v[248:251] offset:320
    ds_write_b128 v28, v[88:91] offset:336
    ds_write_b128 v28, v[252:255] offset:352
    ds_write_b128 v28, v[92:95] offset:368
    v_lshrrev_b32 v2, 5, v1
    v_and_b32 v3, 31, v1
    v_mul_u32_u24 v48, 528, v2
    v_lshl_add_u32 v48, v3, 4, v48
    s_mul_i32 s5, s4, 16896
    v_add_u32 v48, s5, v48
    v_lshlrev_b32 v49, 16, v2
    v_lshl_add_u32 v49, v3, 4, v49
    s_waitcnt lgkmcnt(0)
    ds_read_b128 v[128:131], v48 offset:0
    ds_read_b128 v[132:135], v48 offset:1056
    ds_read_b128 v[136:139], v48 offset:2112
    ds_read_b128 v[140:143], v48 offset:3168
    ds_read_b128 v[144:147], v48 offset:4224
    ds_read_b128 v[148:151], v48 offset:5280
    ds_read_b128 v[152:155], v48 offset:6336
    ds_read_b128 v[156:159], v48 offset:7392
    ds_read_b128 v[160:163], v48 offset:8448
    ds_read_b128 v[164:167], v48 offset:9504
    ds_read_b128 v[168:171], v48 offset:10560
    ds_read_b128 v[172:175], v48 offset:11616
    ds_read_b128 v[176:179], v48 offset:12672
    ds_read_b128 v[180:183], v48 offset:13728
    ds_read_b128 v[184:187], v48 offset:14784
    ds_read_b128 v[188:191], v48 offset:15840
    s_waitcnt lgkmcnt(15)
    s_add_u32 s5, s52, 0
    buffer_store_dwordx4 v[128:131], v49, s[24:27], s5 offen sc1
    s_waitcnt lgkmcnt(14)
    s_add_u32 s5, s52, 131072
    buffer_store_dwordx4 v[132:135], v49, s[24:27], s5 offen sc1
    s_waitcnt lgkmcnt(13)
    s_add_u32 s5, s52, 262144
    buffer_store_dwordx4 v[136:139], v49, s[24:27], s5 offen sc1
    s_waitcnt lgkmcnt(12)
    s_add_u32 s5, s52, 393216
    buffer_store_dwordx4 v[140:143], v49, s[24:27], s5 offen sc1
    s_waitcnt lgkmcnt(11)
    s_add_u32 s5, s52, 524288
    buffer_store_dwordx4 v[144:147], v49, s[24:27], s5 offen sc1
    s_waitcnt lgkmcnt(10)
    s_add_u32 s5, s52, 655360
    buffer_store_dwordx4 v[148:151], v49, s[24:27], s5 offen sc1
    s_waitcnt lgkmcnt(9)
    s_add_u32 s5, s52, 786432
    buffer_store_dwordx4 v[152:155], v49, s[24:27], s5 offen sc1
    s_waitcnt lgkmcnt(8)
    s_add_u32 s5, s52, 917504
    buffer_store_dwordx4 v[156:159], v49, s[24:27], s5 offen sc1
    s_waitcnt lgkmcnt(7)
    s_add_u32 s5, s52, 1048576
    buffer_store_dwordx4 v[160:163], v49, s[24:27], s5 offen sc1
    s_waitcnt lgkmcnt(6)
    s_add_u32 s5, s52, 1179648
    buffer_store_dwordx4 v[164:167], v49, s[24:27], s5 offen sc1
    s_waitcnt lgkmcnt(5)
    s_add_u32 s5, s52, 1310720
    buffer_store_dwordx4 v[168:171], v49, s[24:27], s5 offen sc1
    s_waitcnt lgkmcnt(4)
    s_add_u32 s5, s52, 1441792
    buffer_store_dwordx4 v[172:175], v49, s[24:27], s5 offen sc1
    s_waitcnt lgkmcnt(3)
    s_add_u32 s5, s52, 1572864
    buffer_store_dwordx4 v[176:179], v49, s[24:27], s5 offen sc1
    s_waitcnt lgkmcnt(2)
    s_add_u32 s5, s52, 1703936
    buffer_store_dwordx4 v[180:183], v49, s[24:27], s5 offen sc1
    s_waitcnt lgkmcnt(1)
    s_add_u32 s5, s52, 1835008
    buffer_store_dwordx4 v[184:187], v49, s[24:27], s5 offen sc1
    s_waitcnt lgkmcnt(0)
    s_add_u32 s5, s52, 1966080
    buffer_store_dwordx4 v[188:191], v49, s[24:27], s5 offen sc1
    s_waitcnt vmcnt(0)
    s_barrier
    s_cmp_lg_u32 s4, 0
    s_cbranch_scc1 L_sig_16
    buffer_store_dword v61, off, s[44:47], s56 sc1
L_sig_16:
L_done:
    s_endpgm
L_code_end:
.section .rodata,"a"
.p2align 6
.amdhsa_kernel gated_mix__spectral_fnet__glu_gated_glu__prompt_kernel
  .amdhsa_next_free_vgpr 512
  .amdhsa_next_free_sgpr 102
  .amdhsa_accum_offset 256
  .amdhsa_group_segment_fixed_size 0
  .amdhsa_kernarg_size 104
  .amdhsa_user_sgpr_count 2
  .amdhsa_user_sgpr_kernarg_segment_ptr 1
  .amdhsa_system_sgpr_workgroup_id_x 1
.end_amdhsa_kernel
```
